```python
import torch

def _softmax(x, axis=-1):
    return torch.softmax(x, dim=axis)
def _gelu(x):
    return torch.nn.functional.gelu(x, approximate="tanh")
def _silu(x):
    return torch.nn.functional.silu(x)
def _sigmoid(x):
    return torch.sigmoid(x)
def _layernorm(x, axis=-1, eps=1e-5):
    m = x.mean(dim=axis, keepdim=True)
    v = x.var(dim=axis, keepdim=True, unbiased=False)
    return (x - m) / torch.sqrt(v + eps)
def _scatter_add(tgt, idx, src, axis=0):
    return tgt.clone().index_add_(axis, idx, src)
def _segment_sum(src, seg, n):
    out = torch.zeros((n,) + src.shape[1:], dtype=src.dtype)
    return out.index_add_(0, seg, src)
def _pad(x, pw):
    flat = tuple(v for pair in reversed(pw) for v in pair)
    return torch.nn.functional.pad(x, flat)

kernel_name = 'sequential_preLN__ssm_conv_s4d__dense_activation_gelu__prompt'

def setup_inputs():

    _w = (lambda a: (lambda t: t.to(torch.bfloat16) if t.is_floating_point() else t)(torch.as_tensor(a)))
    def _A_setup():
        Bsz, L, D, N = 1, 2048, 448, 256
        return {
            "u": _w((lambda *s: torch.randn(*s, dtype=torch.bfloat16) * 0.05)(Bsz, L, D)),
            "log_A_real": _w((lambda *s: torch.randn(*s, dtype=torch.bfloat16) * 6.4)(D, N) * 0.5),
            "A_imag": _w((lambda *s: torch.randn(*s, dtype=torch.bfloat16) * 0.05)(D, N) * 3.14),
            "C_real": _w((lambda *s: torch.randn(*s, dtype=torch.bfloat16) * 0.05)(D, N) / N ** 0.5),
            "C_imag": _w((lambda *s: torch.randn(*s, dtype=torch.bfloat16) * 0.05)(D, N) / N ** 0.5),
            "log_dt": _w((lambda *s: torch.randn(*s, dtype=torch.bfloat16) * 0.05)(D) * 0.5 - 4.0),
            "D_skip": _w((lambda *s: torch.randn(*s, dtype=torch.bfloat16) * 0.05)(D)),
        }
    _A_in = _A_setup()

    def _B_setup():
        B, S, D, F = 1, 2048, 448, 1792
        return {
            "x": _w((lambda *s: torch.randn(*s, dtype=torch.bfloat16) * 0.05)(B, S, D)),
            "w1": _w((lambda *s: torch.randn(*s, dtype=torch.bfloat16) * 0.8)(D, F) * (D ** -0.5)),
            "b1": _w((lambda *s: torch.randn(*s, dtype=torch.bfloat16) * 0.2)(F) * 0.01),
            "w2": _w((lambda *s: torch.randn(*s, dtype=torch.bfloat16) * 0.2)(F, D) * (F ** -0.5)),
            "b2": _w((lambda *s: torch.randn(*s, dtype=torch.bfloat16) * 0.2)(D) * 0.01),
        }
    _B_in = _B_setup()

    return {
        "A_u": _A_in["u"],
        "A_log_A_real": _A_in["log_A_real"],
        "A_A_imag": _A_in["A_imag"],
        "A_C_real": _A_in["C_real"],
        "A_C_imag": _A_in["C_imag"],
        "A_log_dt": _A_in["log_dt"],
        "A_D_skip": _A_in["D_skip"],
        "B_x": _B_in["x"],
        "B_w1": _B_in["w1"],
        "B_b1": _B_in["b1"],
        "B_w2": _B_in["w2"],
        "B_b2": _B_in["b2"],
    }

def reference(A_u, A_log_A_real, A_A_imag, A_C_real, A_C_imag, A_log_dt, A_D_skip, B_x, B_w1, B_b1, B_w2, B_b2):
    def _A_ref(u, log_A_real, A_imag, C_real, C_imag, log_dt, D_skip):
        L = u.shape[1]
        dt = torch.exp(log_dt)
        A = -torch.exp(log_A_real) + 1j * A_imag
        C = (C_real + 1j * C_imag) * dt[:, None]
        pos = (lambda x, dt: x.to(dt))(torch.arange(L), log_dt.dtype)
        P = torch.exp((A * dt[:, None])[:, :, None] * pos[None, None, :])
        K = 2.0 * torch.einsum("dn,dnl->dl", C, P).real
        L2 = 2 * L
        u_t = (lambda x, *d: x.permute(*d))(u, 0, 2, 1)
        Kf = (lambda x, *a, **k: torch.fft.rfft(x.float(), *a, **k))(K, L2)
        Uf = (lambda x, *a, **k: torch.fft.rfft(x.float(), *a, **k))(u_t, L2)
        y = (lambda x, *a, **k: torch.fft.irfft(x, *a, **k).to(torch.bfloat16))(Uf * Kf[None, :, :], L2)[:, :, :L]
        y = (lambda x, *d: x.permute(*d))(y, 0, 2, 1)
        return y + u * D_skip[None, None, :]

    def _B_ref(x, w1, b1, w2, b2):
        h = torch.einsum("bsd,df->bsf", x, w1) + b1
        h = _gelu(h)
        return torch.einsum("bsf,fd->bsd", h, w2) + b2

    x = A_u
    h = x + _A_ref(_layernorm(x, axis=-1), A_log_A_real, A_A_imag, A_C_real, A_C_imag, A_log_dt, A_D_skip)
    h2 = h + _B_ref(_layernorm(h, axis=-1), B_w1, B_b1, B_w2, B_b2)
    return h2
```

```asm
; @launch kernel=sequential_preLN__ssm_conv_s4d__dense_activation_gelu__prompt_kernel grid=(256,1,1) block=(512,1,1) lds=161216
.amdgcn_target "amdgcn-amd-amdhsa--gfx950"
.text
.globl sequential_preLN__ssm_conv_s4d__dense_activation_gelu__prompt_kernel
.p2align 8
.type sequential_preLN__ssm_conv_s4d__dense_activation_gelu__prompt_kernel,@function
sequential_preLN__ssm_conv_s4d__dense_activation_gelu__prompt_kernel:
    s_cmp_ge_u32 s2, 256
    s_cbranch_scc1 K1_EXIT
    s_load_dwordx2 s[4:5], s[0:1], 112
    s_load_dwordx2 s[6:7], s[0:1], 0
    s_load_dwordx8 s[8:15], s[0:1], 8
    s_load_dwordx4 s[16:19], s[0:1], 40
    s_load_dwordx2 s[80:81], s[0:1], 64
    s_load_dwordx2 s[82:83], s[0:1], 80
    s_getpc_b64 s[70:71]
    s_and_b32 s70, s70, 0xffffff00
    v_lshlrev_b32 v254, 7, v0
    v_cmp_gt_u32 vcc, 172, v0
    s_and_saveexec_b64 s[72:73], vcc
    s_cbranch_execz K1_CPX
    global_load_dword v255, v254, s[70:71]
K1_CPX:
    s_mov_b64 exec, s[72:73]
K1_CPT:
    v_lshrrev_b32 v1, 6, v0
    v_and_b32 v2, 63, v0
    v_and_b32 v0, 255, v0
    v_readfirstlane_b32 s3, v1
    v_lshlrev_b32 v3, 1, v0
    v_mov_b32 v4, 0
    v_lshlrev_b32 v170, 4, v2
    v_mov_b32 v136, 0
    v_mov_b32 v137, 0
    v_mov_b32 v138, 0
    v_mov_b32 v139, 0
    s_mov_b32 s59, s2
    s_lshl_b32 s22, s59, 3
    s_add_u32 s22, s22, s3
    s_mul_i32 s22, s22, 896
    s_lshr_b32 s51, s3, 2
    s_and_b32 s54, s2, 7
    s_lshl_b32 s54, s54, 1
    s_bfe_u32 s55, s2, 0x10003
    s_or_b32 s54, s54, s55
    s_andn2_b32 s55, s2, 15
    s_or_b32 s54, s54, s55
    v_lshrrev_b32 v168, 1, v0
    s_lshl_b32 s49, s54, 2
    s_lshl_b32 s54, s54, 1
    s_add_u32 s20, s54, s51
    s_lshl_b32 s21, s20, 9
    s_lshl_b32 s23, s20, 1
    s_mov_b64 s[60:61], exec
    v_cmp_gt_u32 vcc, 56, v2
    s_mov_b64 s[62:63], vcc
    s_waitcnt lgkmcnt(0)
    s_mov_b32 s64, s6
    s_mov_b32 s65, s7
    s_and_b32 s65, s65, 0xffff
    s_mov_b32 s66, 0x1c0000
    s_mov_b32 s67, 0x00020000
    s_mov_b64 exec, s[62:63]
    buffer_load_dwordx4 v[136:139], v170, s[64:67], s22 offen
    s_mov_b64 exec, s[60:61]
    s_mov_b32 s68, s4
    s_mov_b32 s69, s5
    s_and_b32 s69, s69, 0xffff
    s_mov_b32 s70, 0x2000000
    s_mov_b32 s71, 0x00020000
    s_cmp_ge_u32 s2, 224
    s_cbranch_scc1 K1_HLD
    s_mov_b32 s24, s8
    s_mov_b32 s25, s9
    s_and_b32 s25, s25, 0xffff
    s_mov_b32 s26, 0x38000
    s_mov_b32 s27, 0x00020000
    s_mov_b32 s40, s16
    s_mov_b32 s41, s17
    s_and_b32 s41, s41, 0xffff
    s_mov_b32 s42, 0x380
    s_mov_b32 s43, 0x00020000
    buffer_load_ushort v8, v3, s[24:27], s21 offen
    buffer_load_ushort v12, v4, s[40:43], s23 offen
    s_mov_b32 s28, s10
    s_mov_b32 s29, s11
    s_and_b32 s29, s29, 0xffff
    s_mov_b32 s30, 0x38000
    s_mov_b32 s31, 0x00020000
    buffer_load_ushort v9, v3, s[28:31], s21 offen
    s_mov_b32 s32, s12
    s_mov_b32 s33, s13
    s_and_b32 s33, s33, 0xffff
    s_mov_b32 s34, 0x38000
    s_mov_b32 s35, 0x00020000
    buffer_load_ushort v10, v3, s[32:35], s21 offen
    s_mov_b32 s36, s14
    s_mov_b32 s37, s15
    s_and_b32 s37, s37, 0xffff
    s_mov_b32 s38, 0x38000
    s_mov_b32 s39, 0x00020000
    buffer_load_ushort v11, v3, s[36:39], s21 offen
    s_load_dword s79, s[18:19], s49
    s_mov_b32 s28, s82
    s_mov_b32 s29, s83
    s_and_b32 s29, s29, 0xffff
    s_mov_b32 s30, 0x188000
    s_mov_b32 s31, 0x00020000
    s_sub_u32 s77, s2, 32
    s_cmp_ge_u32 s2, 196
    s_cselect_b32 s77, s77, s2
    s_mul_hi_u32 s76, s77, 0x24924925
    s_mul_i32 s75, s76, 7
    s_sub_u32 s75, s77, s75
    s_lshl_b32 s74, s76, 2
    s_add_u32 s74, s74, s3
    s_sub_u32 s74, s74, 4
    s_mul_i32 s77, s74, 14336
    s_lshl_b32 s76, s75, 7
    s_add_u32 s77, s77, s76
    s_mul_i32 s76, s75, 229376
    s_lshl_b32 s74, s74, 10
    s_add_u32 s76, s76, s74
    s_add_u32 s27, s76, 0x1988000
    v_lshrrev_b32 v187, 3, v2
    v_mul_u32_u24 v187, 896, v187
    v_and_b32 v5, 7, v2
    v_lshl_add_u32 v187, v5, 4, v187
    s_load_dwordx2 s[88:89], s[0:1], 72
    s_load_dwordx4 s[80:83], s[0:1], 88
    s_lshr_b32 s40, s54, 2
    s_lshl_b32 s40, s40, 15
    s_and_b32 s55, s54, 2
    s_lshl_b32 s55, s55, 5
    s_add_u32 s40, s40, s55
    s_add_u32 s41, s40, 8192
    s_add_u32 s42, s40, 16384
    s_add_u32 s43, s40, 24576
    v_lshlrev_b32 v188, 4, v168
    v_and_b32 v184, 1, v0
    v_lshrrev_b32 v169, 2, v0
    v_lshlrev_b32 v169, 7, v169
    v_and_b32 v189, 3, v0
    v_lshl_add_u32 v169, v189, 4, v169
    v_lshlrev_b32 v189, 3, v168
    v_sub_u32 v189, 74744, v189
    s_mov_b32 s56, 33344
    s_movk_i32 s57, 9216
    v_mad_u32_u24 v189, v184, s56, v189
    v_lshrrev_b32 v190, 3, v168
    v_add_u32 v190, v190, v168
    v_lshlrev_b32 v190, 4, v190
    v_add_u32 v190, 55296, v190
    v_mad_u32_u24 v190, v184, s57, v190
    v_cmp_eq_u32 s[16:17], 1, v184
    v_lshrrev_b32 v118, 1, v2
    v_and_b32 v119, 1, v2
    s_lshl_b32 s72, s3, 5
    v_add_u32 v118, s72, v118
    v_mul_u32_u24 v191, 33344, v119
    v_lshl_add_u32 v191, v118, 4, v191
    v_add_u32 v191, 73728, v191
    s_cmp_lg_u32 s3, 0
    s_cbranch_scc1 K1_NOTZ
    v_mov_b32 v56, 0
    v_mov_b32 v57, 0
    v_mov_b32 v58, 0
    v_mov_b32 v59, 0
    v_bfe_u32 v60, v0, 2, 3
    v_mul_u32_u24 v60, 4160, v60
    v_and_b32 v61, 3, v0
    v_lshl_add_u32 v60, v61, 4, v60
    v_lshrrev_b32 v61, 5, v0
    v_mul_u32_u24 v61, 33344, v61
    s_mov_b32 s72, 77824
    v_add3_u32 v60, v60, v61, s72
    ds_write_b128 v60, v[56:59]
K1_NOTZ:
    s_mov_b32 s55, 0x7fff
    v_lshlrev_b32 v112, 3, v0
    v_add_u32 v120, 0, v112
    v_add_u32 v121, 1, v112
    v_add_u32 v122, 2, v112
    v_add_u32 v123, 3, v112
    v_add_u32 v124, 4, v112
    v_add_u32 v125, 5, v112
    v_add_u32 v126, 6, v112
    v_add_u32 v127, 7, v112
    v_cvt_f32_u32 v176, v120
    v_cvt_f32_u32 v177, v121
    v_cvt_f32_u32 v178, v122
    v_cvt_f32_u32 v179, v123
    v_cvt_f32_u32 v180, v124
    v_cvt_f32_u32 v181, v125
    v_cvt_f32_u32 v182, v126
    v_cvt_f32_u32 v183, v127
    v_bfe_u32 v128, v176, 16, 1
    v_bfe_u32 v129, v177, 16, 1
    v_bfe_u32 v130, v178, 16, 1
    v_bfe_u32 v131, v179, 16, 1
    v_bfe_u32 v132, v180, 16, 1
    v_bfe_u32 v133, v181, 16, 1
    v_bfe_u32 v134, v182, 16, 1
    v_bfe_u32 v135, v183, 16, 1
    v_add3_u32 v176, v176, v128, s55
    v_add3_u32 v177, v177, v129, s55
    v_add3_u32 v178, v178, v130, s55
    v_add3_u32 v179, v179, v131, s55
    v_add3_u32 v180, v180, v132, s55
    v_add3_u32 v181, v181, v133, s55
    v_add3_u32 v182, v182, v134, s55
    v_add3_u32 v183, v183, v135, s55
    v_lshrrev_b32 v176, 16, v176
    v_lshrrev_b32 v177, 16, v177
    v_lshrrev_b32 v178, 16, v178
    v_lshrrev_b32 v179, 16, v179
    v_lshrrev_b32 v180, 16, v180
    v_lshrrev_b32 v181, 16, v181
    v_lshrrev_b32 v182, 16, v182
    v_lshrrev_b32 v183, 16, v183
    v_subrev_u32 v176, 0x4280, v176
    v_subrev_u32 v177, 0x4280, v177
    v_subrev_u32 v178, 0x4280, v178
    v_subrev_u32 v179, 0x4280, v179
    v_subrev_u32 v180, 0x4280, v180
    v_subrev_u32 v181, 0x4280, v181
    v_subrev_u32 v182, 0x4280, v182
    v_subrev_u32 v183, 0x4280, v183
    v_cmp_gt_u32 vcc, 32, v0
    s_mul_i32 s55, s51, 3072
    s_add_u32 s55, s55, 140416
    v_mov_b32 v112, s55
    v_cndmask_b32 v176, v176, v120, vcc
    v_cndmask_b32 v177, v177, v121, vcc
    v_cndmask_b32 v178, v178, v122, vcc
    v_cndmask_b32 v179, v179, v123, vcc
    v_cndmask_b32 v180, v180, v124, vcc
    v_cndmask_b32 v181, v181, v125, vcc
    v_cndmask_b32 v182, v182, v126, vcc
    v_cndmask_b32 v183, v183, v127, vcc
    v_lshl_add_u32 v176, v176, 2, v112
    v_lshl_add_u32 v177, v177, 2, v112
    v_lshl_add_u32 v178, v178, 2, v112
    v_lshl_add_u32 v179, v179, 2, v112
    v_lshl_add_u32 v180, v180, 2, v112
    v_lshl_add_u32 v181, v181, 2, v112
    v_lshl_add_u32 v182, v182, 2, v112
    v_lshl_add_u32 v183, v183, 2, v112
    s_mul_i32 s10, s51, 33344
    s_add_u32 s10, s10, 73728
    s_mul_i32 s9, s51, 7680
    s_add_u32 s9, s9, 4096
    v_lshlrev_b32 v208, 4, v0
    v_add_u32 v208, s9, v208
    v_lshrrev_b32 v207, 2, v0
    v_mul_u32_u24 v207, 96, v207
    v_and_b32 v112, 3, v0
    v_lshl_add_u32 v207, v112, 4, v207
    v_add_u32 v207, s9, v207
    s_and_b32 s6, s3, 3
    s_sub_u32 s7, 3, s6
    v_and_b32 v113, 15, v2
    v_lshrrev_b32 v114, 4, v2
    v_and_b32 v115, 7, v113
    v_sub_u32 v115, 7, v115
    v_mul_u32_u24 v115, 4160, v115
    v_lshrrev_b32 v116, 3, v113
    v_sub_u32 v116, v114, v116
    v_lshl_add_u32 v115, v116, 4, v115
    s_add_u32 s55, s10, 3600
    v_add_u32 v200, s55, v115
    v_mul_u32_u24 v116, 96, v113
    v_lshl_add_u32 v116, v114, 4, v116
    s_add_u32 s55, s9, -672
    v_add_u32 v201, s55, v116
    s_lshl_b32 s55, s6, 8
    s_add_u32 s55, s55, 2816
    v_subrev_u32 v202, s55, v200
    s_mul_i32 s55, s6, 384
    s_sub_u32 s55, 384, s55
    v_add_u32 v203, s55, v201
    s_mul_i32 s55, s51, 24576
    s_add_u32 s55, s55, 19456
    v_lshlrev_b32 v204, 4, v2
    v_add_u32 v204, s55, v204
    v_lshlrev_b32 v115, 5, v113
    v_lshl_add_u32 v115, v114, 2, v115
    s_lshl_b32 s55, s7, 9
    v_add_u32 v115, s55, v115
    v_lshlrev_b32 v205, 1, v115
    v_mul_u32_u24 v206, 144, v113
    v_lshl_add_u32 v206, v114, 4, v206
    s_mul_i32 s55, s7, 2304
    s_mul_i32 s12, s51, 9216
    s_add_u32 s55, s55, s12
    s_add_u32 s55, s55, 55296
    v_add_u32 v206, s55, v206
    s_lshl_b32 s11, s20, 12
    s_add_u32 s11, s11, 0xc00000
    s_mov_b32 s47, 0xffff0000
    s_mov_b32 s57, 0x0000bf80
    s_mov_b32 s58, 0xbf800000
    v_mov_b32 v172, -1
    v_mov_b32 v173, -1
    v_mov_b32 v174, -1
    v_mov_b32 v175, -1
    v_lshlrev_b32 v171, 4, v0
    s_and_b32 s73, s2, 7
    s_lshl_b32 s73, s73, 14
    s_add_u32 s73, s73, 0x1d00000
    s_mov_b32 s44, 0x3fb8aa3b
    s_mov_b32 s45, 0x32a57060
    s_mov_b32 s46, 0x3f317218
    s_mov_b32 s48, 0x3e22f983
    s_mul_i32 s50, s3, 4608
    s_mov_b32 m0, s50
    v_and_b32 v5, 15, v2
    v_lshrrev_b32 v6, 4, v2
    v_mul_u32_u24 v7, 288, v5
    v_lshl_add_u32 v7, v6, 4, v7
    v_add_u32 v7, s50, v7
    v_lshrrev_b32 v1, 1, v6
    v_lshlrev_b32 v1, 9, v1
    v_and_b32 v14, 1, v6
    v_lshl_add_u32 v1, v14, 4, v1
    v_lshl_add_u32 v1, v5, 5, v1
    v_add_u32 v1, s50, v1
    v_lshlrev_b32 v3, 8, v6
    v_add_u32 v3, s50, v3
    v_lshl_add_u32 v13, v5, 2, v3
    v_lshl_add_u32 v14, v5, 4, v3
    v_lshl_add_u32 v15, v5, 3, v3
    v_cmp_gt_u32 vcc, 2, v6
    v_cndmask_b32 v3, v15, v14, vcc
    v_add_u32 v14, 8, v3
    v_add_u32 v15, 128, v3
    v_cndmask_b32 v4, v15, v14, vcc
    v_lshlrev_b32 v186, 2, v0
    s_mul_i32 s21, s51, 3072
    s_add_u32 s21, s21, 140416
    v_add_u32 v185, s21, v186
    s_mul_i32 s21, s51, 18432
    v_add_u32 v186, s21, v186
    s_branch K1_LN
K1_HLD:
    s_sub_u32 s44, s2, 224
    s_lshl_b32 s45, s3, 5
    s_add_u32 s44, s44, s45
    s_cmp_ge_u32 s44, 196
    s_cselect_b32 s45, 0, s44
    s_cselect_b32 s41, -1, s44
    v_lshlrev_b32 v213, 4, v2
    v_lshrrev_b32 v80, 3, v2
    v_and_b32 v81, 7, v2
    v_lshlrev_b32 v81, 4, v81
    s_mov_b32 s24, s82
    s_mov_b32 s25, s83
    s_and_b32 s25, s25, 0xffff
    s_mov_b32 s26, 0x188000
    s_mov_b32 s27, 0x00020000
    s_mul_hi_u32 s32, s45, 0x24924925
    s_mul_i32 s33, s32, 7
    s_sub_u32 s33, s45, s33
    s_mul_i32 s36, s33, 229376
    s_add_u32 s36, s36, 0x1988000
    s_mov_b32 s38, 114688
    v_mul_u32_u24 v82, 896, v80
    v_add_u32 v82, v82, v81
    s_mul_i32 s34, s32, 57344
    s_lshl_b32 s33, s33, 7
    s_add_u32 s34, s34, s33
    s_mov_b32 s28, s80
    s_mov_b32 s29, s81
    s_and_b32 s29, s29, 0xffff
    s_mov_b32 s30, 0x188000
    s_mov_b32 s31, 0x00020000
    v_mul_u32_u24 v83, 3584, v80
    v_add_u32 v83, v83, v81
    s_mul_i32 s8, s33, 1792
    s_lshl_b32 s9, s32, 7
    s_add_u32 s8, s8, s9
    buffer_load_dwordx4 v[224:227], v83, s[28:31], s8 offen
    s_add_u32 s8, s8, 28672
    buffer_load_dwordx4 v[228:231], v83, s[28:31], s8 offen
    s_add_u32 s8, s8, 28672
    buffer_load_dwordx4 v[232:235], v83, s[28:31], s8 offen
    s_add_u32 s8, s8, 28672
    buffer_load_dwordx4 v[236:239], v83, s[28:31], s8 offen
    s_add_u32 s8, s8, 28672
    s_mul_i32 s9, s32, 57344
    s_lshl_b32 s10, s33, 5
    s_add_u32 s9, s9, s10
    s_add_u32 s9, s9, 0x1800000
    s_lshr_b32 s10, s32, 2
    s_lshl_b32 s10, s10, 13
    s_and_b32 s11, s32, 3
    s_lshl_b32 s11, s11, 5
    s_add_u32 s10, s10, s11
    s_lshr_b32 s11, s33, 5
    s_add_u32 s10, s10, s11
    s_add_u32 s10, s10, 0x1d40000
    v_lshlrev_b32 v209, 8, v2
    s_mul_i32 s11, s3, 14336
    s_lshl_b32 s12, s2, 2
    s_add_u32 s11, s11, s12
    s_add_u32 s11, s11, 0x1d3fd00
    s_mov_b32 s47, 0xffff0000
    s_lshl_b32 s37, s32, 12
    s_add_u32 s36, s36, s37
    s_mul_i32 s37, s3, 12288
    v_mul_u32_u24 v210, 192, v80
    v_add3_u32 v210, v210, v81, s37
    v_bfe_u32 v84, v2, 2, 2
    v_mul_u32_u24 v84, 192, v84
    v_lshrrev_b32 v85, 5, v2
    v_mul_u32_u24 v85, 768, v85
    v_add3_u32 v84, v84, v85, s37
    v_and_b32 v85, 3, v2
    v_lshl_add_u32 v84, v85, 3, v84
    v_bfe_u32 v85, v2, 4, 1
    v_lshl_add_u32 v211, v85, 5, v84
    v_add_u32 v212, 1536, v211
    v_lshrrev_b32 v85, 5, v2
    v_mul_u32_u24 v85, 768, v85
    v_add_u32 v207, v211, v85
    v_add_u32 v208, 768, v207
K1_LN:
    v_mov_b32 v140, 0
    v_mov_b32 v141, 0
    v_mov_b32 v142, 0
    v_mov_b32 v143, 0
    s_mov_b32 s74, 0x3b124925
    s_mov_b32 s75, 0x3727c5ac
    s_mov_b32 s76, 0x3f803f80
    s_mov_b32 s14, 0x5a3c96e1
    s_mov_b32 s15, 0x1b7d42c9
    v_mov_b32 v192, s14
    v_mov_b32 v193, s15
    v_mov_b32 v194, v192
    v_mov_b32 v195, v193
    v_lshrrev_b32 v196, 2, v2
    v_lshlrev_b32 v196, 14, v196
    v_and_b32 v197, 3, v2
    v_lshl_add_u32 v196, v197, 4, v196
    v_lshlrev_b32 v197, 14, v2
    s_lshl_b32 s72, s2, 6
    s_add_u32 s72, s72, 0x1d00000
    s_lshl_b32 s78, s2, 3
    s_add_u32 s78, s78, s3
    s_lshl_b32 s78, s78, 2
    s_add_u32 s78, s78, 0x1d00000
    s_mul_i32 s55, s3, 912
    s_add_u32 s55, s55, 146624
    v_add_u32 v170, s55, v170
    v_bfe_u32 v150, v2, 2, 2
    v_lshrrev_b32 v151, 5, v2
    v_lshl_add_u32 v152, v151, 2, v150
    v_xor_b32 v153, 3, v152
    v_and_b32 v154, 3, v2
    v_lshlrev_b32 v154, 3, v154
    v_bfe_u32 v155, v2, 4, 1
    v_lshl_add_u32 v154, v155, 5, v154
    s_lshl_b32 s55, s3, 6
    s_add_u32 s55, s55, 146624
    v_add_u32 v154, s55, v154
    s_movk_i32 s56, 912
    v_mad_u32_u24 v161, v153, s56, v154
    v_mad_u32_u24 v162, v152, s56, v154
    v_lshl_add_u32 v163, v155, 2, v150
    v_lshlrev_b32 v163, 15, v163
    v_bfe_u32 v150, v2, 1, 1
    v_lshl_add_u32 v163, v150, 6, v163
    s_lshl_b32 s59, s2, 7
    v_lshl_add_u32 v163, v151, 5, v163
    v_and_b32 v150, 1, v2
    v_lshl_add_u32 v163, v150, 4, v163
    s_lshl_b32 s55, s3, 18
    s_add_u32 s59, s59, s55
    s_mov_b32 s58, 0x5a3cc6e1
    s_cmp_ge_u32 s2, 224
    s_cbranch_scc1 K1_W0
    s_waitcnt vmcnt(5)
    s_branch K1_W1
K1_W0:
    s_waitcnt vmcnt(4)
K1_W1:
    v_dot2_f32_bf16 v140, v136, s76, v140
    v_dot2_f32_bf16 v141, v136, v136, v141
    v_dot2_f32_bf16 v142, v137, s76, v142
    v_dot2_f32_bf16 v143, v137, v137, v143
    v_dot2_f32_bf16 v140, v138, s76, v140
    v_dot2_f32_bf16 v141, v138, v138, v141
    v_dot2_f32_bf16 v142, v139, s76, v142
    v_dot2_f32_bf16 v143, v139, v139, v143
    s_mov_b64 exec, s[62:63]
    ds_write_b128 v170, v[136:139] offset:7296
    s_mov_b64 exec, s[60:61]
    s_nop 0
    v_pk_add_f32 v[140:141], v[140:141], v[142:143]
    s_nop 0
    v_add_f32_dpp v140, v140, v140 quad_perm:[1,0,3,2] row_mask:0xf bank_mask:0xf
    v_add_f32_dpp v141, v141, v141 quad_perm:[1,0,3,2] row_mask:0xf bank_mask:0xf
    s_nop 0
    v_add_f32_dpp v140, v140, v140 quad_perm:[2,3,0,1] row_mask:0xf bank_mask:0xf
    v_add_f32_dpp v141, v141, v141 quad_perm:[2,3,0,1] row_mask:0xf bank_mask:0xf
    s_nop 0
    v_add_f32_dpp v140, v140, v140 row_half_mirror row_mask:0xf bank_mask:0xf
    v_add_f32_dpp v141, v141, v141 row_half_mirror row_mask:0xf bank_mask:0xf
    s_nop 0
    v_add_f32_dpp v140, v140, v140 row_mirror row_mask:0xf bank_mask:0xf
    v_add_f32_dpp v141, v141, v141 row_mirror row_mask:0xf bank_mask:0xf
    v_mov_b32 v144, v140
    v_mov_b32 v145, v141
    s_nop 0
    v_permlane16_swap_b32 v140, v144
    v_permlane16_swap_b32 v141, v145
    v_pk_add_f32 v[140:141], v[140:141], v[144:145]
    v_mov_b32 v144, v140
    v_mov_b32 v145, v141
    s_nop 0
    v_permlane32_swap_b32 v140, v144
    v_permlane32_swap_b32 v141, v145
    v_pk_add_f32 v[140:141], v[140:141], v[144:145]
    v_mul_f32 v140, s74, v140
    v_mul_f32 v141, s74, v141
    v_fma_f32 v141, -v140, v140, v141
    v_max_f32 v141, 0, v141
    v_cvt_pk_bf16_f32 v141, v141, v141
    v_lshlrev_b32 v141, 16, v141
    v_add_f32 v141, s75, v141
    v_cvt_pk_bf16_f32 v141, v141, v141
    v_lshlrev_b32 v141, 16, v141
    v_sqrt_f32 v141, v141
    v_lshlrev_b32 v148, 16, v136
    v_and_b32 v149, s47, v136
    v_lshlrev_b32 v150, 16, v137
    v_and_b32 v151, s47, v137
    v_lshlrev_b32 v152, 16, v138
    v_and_b32 v153, s47, v138
    v_lshlrev_b32 v154, 16, v139
    v_and_b32 v155, s47, v139
    v_cvt_pk_bf16_f32 v146, -v140, v141
    v_and_b32 v141, s47, v146
    v_rcp_f32 v141, v141
    v_lshlrev_b32 v140, 16, v146
    v_add_f32 v148, v148, v140
    v_add_f32 v149, v149, v140
    v_add_f32 v150, v150, v140
    v_add_f32 v151, v151, v140
    v_add_f32 v152, v152, v140
    v_add_f32 v153, v153, v140
    v_add_f32 v154, v154, v140
    v_add_f32 v155, v155, v140
    v_cvt_pk_bf16_f32 v136, v148, v149
    v_cvt_pk_bf16_f32 v137, v150, v151
    v_cvt_pk_bf16_f32 v138, v152, v153
    v_cvt_pk_bf16_f32 v139, v154, v155
    v_lshlrev_b32 v148, 16, v136
    v_and_b32 v149, s47, v136
    v_lshlrev_b32 v150, 16, v137
    v_and_b32 v151, s47, v137
    v_lshlrev_b32 v152, 16, v138
    v_and_b32 v153, s47, v138
    v_lshlrev_b32 v154, 16, v139
    v_and_b32 v155, s47, v139
    v_mul_f32 v148, v148, v141
    v_mul_f32 v149, v149, v141
    v_mul_f32 v150, v150, v141
    v_mul_f32 v151, v151, v141
    v_mul_f32 v152, v152, v141
    v_mul_f32 v153, v153, v141
    v_mul_f32 v154, v154, v141
    v_mul_f32 v155, v155, v141
    v_cvt_pk_bf16_f32 v136, v148, v149
    v_cvt_pk_bf16_f32 v137, v150, v151
    v_cvt_pk_bf16_f32 v138, v152, v153
    v_cvt_pk_bf16_f32 v139, v154, v155
    s_mov_b64 exec, s[62:63]
    ds_write_b128 v170, v[136:139]
    s_mov_b64 exec, s[60:61]
    s_waitcnt lgkmcnt(0)
    s_barrier
    ds_read_b64_tr_b16 v[104:105], v161
    ds_read_b64_tr_b16 v[106:107], v162 offset:7296
    s_cmp_ge_u32 s3, 6
    s_cbranch_scc1 K1_P2A
    ds_read_b64_tr_b16 v[108:109], v161 offset:512
    ds_read_b64_tr_b16 v[110:111], v162 offset:7808
K1_P2A:
    s_add_u32 s55, s59, 0x200000
    s_cmp_ge_u32 s2, 224
    s_cbranch_scc1 K1_P2W
    s_waitcnt vmcnt(0)
K1_P2W:
    s_mov_b64 exec, 0xff
    buffer_store_dword v146, v197, s[68:71], s78 offen sc1
    s_mov_b64 exec, -1
    s_waitcnt lgkmcnt(0)
    v_xor_b32 v104, s58, v104
    v_xor_b32 v105, s58, v105
    buffer_store_dwordx4 v[104:107], v163, s[68:71], s59 offen sc1
    s_cmp_ge_u32 s3, 6
    s_cbranch_scc1 K1_P2B
    v_xor_b32 v108, s58, v108
    v_xor_b32 v109, s58, v109
    buffer_store_dwordx4 v[108:111], v163, s[68:71], s55 offen sc1
K1_P2B:
    s_cmp_ge_u32 s2, 224
    s_cbranch_scc1 K1_ZERO
    s_cmp_eq_u32 s51, 0
    s_cbranch_scc1 K1_C1
K1_C1:
    v_lshlrev_b32 v8, 16, v8
    v_lshlrev_b32 v9, 16, v9
    v_lshlrev_b32 v10, 16, v10
    v_lshlrev_b32 v11, 16, v11
    v_lshlrev_b32 v12, 16, v12
    v_mul_f32 v14, s44, v12
    v_fma_f32 v15, v12, s44, -v14
    v_fmac_f32 v15, s45, v12
    v_exp_f32 v14, v14
    v_mul_f32 v15, s46, v15
    v_fma_f32 v12, v14, v15, v14
    v_cvt_pk_bf16_f32 v12, v12, v12
    v_lshlrev_b32 v12, 16, v12
    v_mul_f32 v14, s44, v8
    v_fma_f32 v15, v8, s44, -v14
    v_fmac_f32 v15, s45, v8
    v_exp_f32 v14, v14
    v_mul_f32 v15, s46, v15
    v_fma_f32 v8, v14, v15, v14
    v_cvt_pk_bf16_f32 v8, v8, v8
    v_lshlrev_b32 v8, 16, v8
    v_mul_f32 v8, v8, v12
    v_mul_f32 v9, v9, v12
    v_mul_f32 v8, s44, v8
    v_mul_f32 v9, s48, v9
    v_mul_f32 v72, 0x44800000, v10
    v_mul_f32 v73, 0xc4800000, v11
    v_mul_f32 v12, 0x33800000, v12
    s_mov_b32 s52, 0x47000000
    s_mov_b32 s53, s52
    v_mov_b32 v136, v8
    v_mov_b32 v137, v9
    v_pk_add_f32 v[138:139], v[136:137], v[136:137]
    v_pk_add_f32 v[140:141], v[138:139], v[138:139]
    v_pk_add_f32 v[142:143], v[140:141], v[140:141]
    v_pk_add_f32 v[144:145], v[142:143], v[142:143]
    v_pk_add_f32 v[146:147], v[144:145], v[144:145]
    v_pk_add_f32 v[148:149], v[146:147], v[146:147]
    v_pk_add_f32 v[150:151], v[148:149], v[148:149]
    v_pk_add_f32 v[152:153], v[150:151], v[150:151]
    v_pk_add_f32 v[154:155], v[152:153], v[152:153]
    v_pk_add_f32 v[156:157], v[154:155], v[154:155]
    v_pk_add_f32 v[158:159], v[156:157], v[156:157]
    v_exp_f32 v142, -v142
    v_fract_f32 v143, v143
    v_exp_f32 v144, -v144
    v_fract_f32 v145, v145
    v_exp_f32 v146, -v146
    v_fract_f32 v147, v147
    v_exp_f32 v148, -v148
    v_fract_f32 v149, v149
    v_cos_f32 v22, v143
    v_sin_f32 v23, v143
    v_cos_f32 v24, v145
    v_sin_f32 v25, v145
    v_cos_f32 v26, v147
    v_sin_f32 v27, v147
    v_cos_f32 v28, v149
    v_sin_f32 v29, v149
    s_nop 0
    v_pk_mul_f32 v[22:23], v[22:23], v[142:143] op_sel:[0,0] op_sel_hi:[1,0]
    v_pk_mul_f32 v[24:25], v[24:25], v[144:145] op_sel:[0,0] op_sel_hi:[1,0]
    v_pk_mul_f32 v[26:27], v[26:27], v[146:147] op_sel:[0,0] op_sel_hi:[1,0]
    v_pk_mul_f32 v[28:29], v[28:29], v[148:149] op_sel:[0,0] op_sel_hi:[1,0]
    v_exp_f32 v136, -v136
    v_fract_f32 v137, v137
    v_exp_f32 v138, -v138
    v_fract_f32 v139, v139
    v_exp_f32 v140, -v140
    v_fract_f32 v141, v141
    v_exp_f32 v150, -v150
    v_fract_f32 v151, v151
    v_cos_f32 v16, v137
    v_sin_f32 v17, v137
    v_cos_f32 v18, v139
    v_sin_f32 v19, v139
    v_cos_f32 v20, v141
    v_sin_f32 v21, v141
    v_cos_f32 v30, v151
    v_sin_f32 v31, v151
    s_nop 0
    v_pk_mul_f32 v[16:17], v[16:17], v[136:137] op_sel:[0,0] op_sel_hi:[1,0]
    v_pk_mul_f32 v[18:19], v[18:19], v[138:139] op_sel:[0,0] op_sel_hi:[1,0]
    v_pk_mul_f32 v[20:21], v[20:21], v[140:141] op_sel:[0,0] op_sel_hi:[1,0]
    v_pk_mul_f32 v[30:31], v[30:31], v[150:151] op_sel:[0,0] op_sel_hi:[1,0]
    v_exp_f32 v152, -v152
    v_fract_f32 v153, v153
    v_exp_f32 v154, -v154
    v_fract_f32 v155, v155
    v_exp_f32 v156, -v156
    v_fract_f32 v157, v157
    v_exp_f32 v158, -v158
    v_fract_f32 v159, v159
    v_cos_f32 v32, v153
    v_sin_f32 v33, v153
    v_cos_f32 v34, v155
    v_sin_f32 v35, v155
    v_cos_f32 v36, v157
    v_sin_f32 v37, v157
    v_cos_f32 v38, v159
    v_sin_f32 v39, v159
    s_nop 0
    v_pk_mul_f32 v[32:33], v[32:33], v[152:153] op_sel:[0,0] op_sel_hi:[1,0]
    v_pk_mul_f32 v[34:35], v[34:35], v[154:155] op_sel:[0,0] op_sel_hi:[1,0]
    v_pk_mul_f32 v[36:37], v[36:37], v[156:157] op_sel:[0,0] op_sel_hi:[1,0]
    v_pk_mul_f32 v[38:39], v[38:39], v[158:159] op_sel:[0,0] op_sel_hi:[1,0]
    v_mov_b32 v40, s52
    v_mov_b32 v41, 0
    v_pk_mul_f32 v[42:43], v[22:23], s[52:53]
    v_pk_mul_f32 v[44:45], v[24:25], s[52:53]
    v_pk_mul_f32 v[8:9], v[24:25], v[42:43] op_sel:[1,1] op_sel_hi:[1,0]
    v_pk_fma_f32 v[46:47], v[24:25], v[42:43], v[8:9] op_sel:[0,0,0] op_sel_hi:[0,1,1] neg_lo:[0,0,1]
    v_pk_mul_f32 v[48:49], v[26:27], s[52:53]
    v_pk_mul_f32 v[10:11], v[26:27], v[42:43] op_sel:[1,1] op_sel_hi:[1,0]
    v_pk_fma_f32 v[50:51], v[26:27], v[42:43], v[10:11] op_sel:[0,0,0] op_sel_hi:[0,1,1] neg_lo:[0,0,1]
    v_pk_mul_f32 v[8:9], v[26:27], v[44:45] op_sel:[1,1] op_sel_hi:[1,0]
    v_pk_fma_f32 v[52:53], v[26:27], v[44:45], v[8:9] op_sel:[0,0,0] op_sel_hi:[0,1,1] neg_lo:[0,0,1]
    v_pk_mul_f32 v[10:11], v[26:27], v[46:47] op_sel:[1,1] op_sel_hi:[1,0]
    v_pk_fma_f32 v[54:55], v[26:27], v[46:47], v[10:11] op_sel:[0,0,0] op_sel_hi:[0,1,1] neg_lo:[0,0,1]
    v_pk_mul_f32 v[56:57], v[28:29], s[52:53]
    v_pk_mul_f32 v[8:9], v[28:29], v[42:43] op_sel:[1,1] op_sel_hi:[1,0]
    v_pk_fma_f32 v[58:59], v[28:29], v[42:43], v[8:9] op_sel:[0,0,0] op_sel_hi:[0,1,1] neg_lo:[0,0,1]
    v_pk_mul_f32 v[10:11], v[28:29], v[44:45] op_sel:[1,1] op_sel_hi:[1,0]
    v_pk_fma_f32 v[60:61], v[28:29], v[44:45], v[10:11] op_sel:[0,0,0] op_sel_hi:[0,1,1] neg_lo:[0,0,1]
    v_pk_mul_f32 v[8:9], v[28:29], v[46:47] op_sel:[1,1] op_sel_hi:[1,0]
    v_pk_fma_f32 v[62:63], v[28:29], v[46:47], v[8:9] op_sel:[0,0,0] op_sel_hi:[0,1,1] neg_lo:[0,0,1]
    v_pk_mul_f32 v[10:11], v[28:29], v[48:49] op_sel:[1,1] op_sel_hi:[1,0]
    v_pk_fma_f32 v[64:65], v[28:29], v[48:49], v[10:11] op_sel:[0,0,0] op_sel_hi:[0,1,1] neg_lo:[0,0,1]
    v_pk_mul_f32 v[8:9], v[28:29], v[50:51] op_sel:[1,1] op_sel_hi:[1,0]
    v_pk_fma_f32 v[66:67], v[28:29], v[50:51], v[8:9] op_sel:[0,0,0] op_sel_hi:[0,1,1] neg_lo:[0,0,1]
    v_pk_mul_f32 v[10:11], v[28:29], v[52:53] op_sel:[1,1] op_sel_hi:[1,0]
    v_pk_fma_f32 v[68:69], v[28:29], v[52:53], v[10:11] op_sel:[0,0,0] op_sel_hi:[0,1,1] neg_lo:[0,0,1]
    v_pk_mul_f32 v[8:9], v[28:29], v[54:55] op_sel:[1,1] op_sel_hi:[1,0]
    v_pk_fma_f32 v[70:71], v[28:29], v[54:55], v[8:9] op_sel:[0,0,0] op_sel_hi:[0,1,1] neg_lo:[0,0,1]
    v_cvt_pk_f16_f32 v14, v40, v41
    v_cvt_pk_f16_f32 v15, v42, v43
    v_cvt_pk_f16_f32 v5, v44, v45
    v_cvt_pk_f16_f32 v6, v46, v47
    ds_write_addtid_b32 v14 offset:0
    ds_write_addtid_b32 v15 offset:288
    ds_write_addtid_b32 v5 offset:576
    ds_write_addtid_b32 v6 offset:864
    v_cvt_pk_f16_f32 v14, v48, v49
    v_cvt_pk_f16_f32 v15, v50, v51
    v_cvt_pk_f16_f32 v5, v52, v53
    v_cvt_pk_f16_f32 v6, v54, v55
    ds_write_addtid_b32 v14 offset:1152
    ds_write_addtid_b32 v15 offset:1440
    ds_write_addtid_b32 v5 offset:1728
    ds_write_addtid_b32 v6 offset:2016
    v_cvt_pk_f16_f32 v14, v56, v57
    v_cvt_pk_f16_f32 v15, v58, v59
    v_cvt_pk_f16_f32 v5, v60, v61
    v_cvt_pk_f16_f32 v6, v62, v63
    ds_write_addtid_b32 v14 offset:2304
    ds_write_addtid_b32 v15 offset:2592
    ds_write_addtid_b32 v5 offset:2880
    ds_write_addtid_b32 v6 offset:3168
    v_cvt_pk_f16_f32 v14, v64, v65
    v_cvt_pk_f16_f32 v15, v66, v67
    v_cvt_pk_f16_f32 v5, v68, v69
    v_cvt_pk_f16_f32 v6, v70, v71
    ds_write_addtid_b32 v14 offset:3456
    ds_write_addtid_b32 v15 offset:3744
    ds_write_addtid_b32 v5 offset:4032
    ds_write_addtid_b32 v6 offset:4320
    s_cmp_eq_u32 s51, 0
    s_cbranch_scc1 K1_C2
    s_sub_u32 s75, s11, 4096
    buffer_store_dwordx4 v[172:175], v171, s[68:71], s11 offen sc1
    buffer_store_dwordx4 v[172:175], v171, s[68:71], s75 offen sc1
    s_cmp_ge_u32 s2, 32
    s_cbranch_scc1 K1_NZS
    s_cmp_ge_u32 s3, 6
    s_cbranch_scc1 K1_NZS
    v_mov_b32 v112, 0
    v_mov_b32 v113, 0
    v_mov_b32 v114, 0
    v_mov_b32 v115, 0
    s_lshl_b32 s75, s2, 10
    s_lshl_b32 s74, s2, 7
    s_add_u32 s74, s74, 31744
    s_cmp_eq_u32 s3, 4
    s_cselect_b32 s75, s75, s74
    s_cselect_b32 exec_lo, -1, 0xff
    s_cselect_b32 exec_hi, -1, 0
    s_add_u32 s75, s75, 0x1c00000
    buffer_store_dwordx4 v[112:115], v171, s[68:71], s75 offen sc1
    s_mov_b64 exec, -1
K1_NZS:
K1_C2:
    v_pk_mul_f32 v[10:11], v[16:17], v[72:73] op_sel:[1,1] op_sel_hi:[1,0]
    v_pk_fma_f32 v[74:75], v[16:17], v[72:73], v[10:11] op_sel:[0,0,0] op_sel_hi:[0,1,1] neg_hi:[0,0,1]
    v_pk_mul_f32 v[8:9], v[18:19], v[72:73] op_sel:[1,1] op_sel_hi:[1,0]
    v_pk_fma_f32 v[76:77], v[18:19], v[72:73], v[8:9] op_sel:[0,0,0] op_sel_hi:[0,1,1] neg_hi:[0,0,1]
    v_pk_mul_f32 v[10:11], v[18:19], v[74:75] op_sel:[1,1] op_sel_hi:[1,0]
    v_pk_fma_f32 v[78:79], v[18:19], v[74:75], v[10:11] op_sel:[0,0,0] op_sel_hi:[0,1,1] neg_hi:[0,0,1]
    v_pk_mul_f32 v[8:9], v[20:21], v[72:73] op_sel:[1,1] op_sel_hi:[1,0]
    v_pk_fma_f32 v[80:81], v[20:21], v[72:73], v[8:9] op_sel:[0,0,0] op_sel_hi:[0,1,1] neg_hi:[0,0,1]
    v_pk_mul_f32 v[10:11], v[20:21], v[74:75] op_sel:[1,1] op_sel_hi:[1,0]
    v_pk_fma_f32 v[82:83], v[20:21], v[74:75], v[10:11] op_sel:[0,0,0] op_sel_hi:[0,1,1] neg_hi:[0,0,1]
    v_pk_mul_f32 v[8:9], v[20:21], v[76:77] op_sel:[1,1] op_sel_hi:[1,0]
    v_pk_fma_f32 v[84:85], v[20:21], v[76:77], v[8:9] op_sel:[0,0,0] op_sel_hi:[0,1,1] neg_hi:[0,0,1]
    v_pk_mul_f32 v[10:11], v[20:21], v[78:79] op_sel:[1,1] op_sel_hi:[1,0]
    v_pk_fma_f32 v[86:87], v[20:21], v[78:79], v[10:11] op_sel:[0,0,0] op_sel_hi:[0,1,1] neg_hi:[0,0,1]
    s_cmp_eq_u32 s51, 0
    s_cbranch_scc1 K1_C3
    s_add_u32 s26, s77, 7168
    buffer_load_dwordx4 v[216:219], v187, s[28:31], s77 offen
    buffer_load_dwordx4 v[220:223], v187, s[28:31], s26 offen
K1_C3:
    ds_read_b128 v[40:43], v7 offset:0
    ds_read_b128 v[44:47], v7 offset:64
    ds_read_b128 v[48:51], v7 offset:128
    ds_read_b128 v[52:55], v7 offset:192
    v_pk_mul_f32 v[8:9], v[30:31], v[72:73] op_sel:[1,1] op_sel_hi:[1,0]
    v_pk_fma_f32 v[88:89], v[30:31], v[72:73], v[8:9] op_sel:[0,0,0] op_sel_hi:[0,1,1] neg_hi:[0,0,1]
    v_pk_mul_f32 v[10:11], v[30:31], v[74:75] op_sel:[1,1] op_sel_hi:[1,0]
    v_pk_fma_f32 v[90:91], v[30:31], v[74:75], v[10:11] op_sel:[0,0,0] op_sel_hi:[0,1,1] neg_hi:[0,0,1]
    v_pk_mul_f32 v[8:9], v[30:31], v[76:77] op_sel:[1,1] op_sel_hi:[1,0]
    v_pk_fma_f32 v[92:93], v[30:31], v[76:77], v[8:9] op_sel:[0,0,0] op_sel_hi:[0,1,1] neg_hi:[0,0,1]
    v_pk_mul_f32 v[10:11], v[30:31], v[78:79] op_sel:[1,1] op_sel_hi:[1,0]
    v_pk_fma_f32 v[94:95], v[30:31], v[78:79], v[10:11] op_sel:[0,0,0] op_sel_hi:[0,1,1] neg_hi:[0,0,1]
    v_pk_mul_f32 v[8:9], v[30:31], v[80:81] op_sel:[1,1] op_sel_hi:[1,0]
    v_pk_fma_f32 v[96:97], v[30:31], v[80:81], v[8:9] op_sel:[0,0,0] op_sel_hi:[0,1,1] neg_hi:[0,0,1]
    v_pk_mul_f32 v[10:11], v[30:31], v[82:83] op_sel:[1,1] op_sel_hi:[1,0]
    v_pk_fma_f32 v[98:99], v[30:31], v[82:83], v[10:11] op_sel:[0,0,0] op_sel_hi:[0,1,1] neg_hi:[0,0,1]
    v_pk_mul_f32 v[8:9], v[30:31], v[84:85] op_sel:[1,1] op_sel_hi:[1,0]
    v_pk_fma_f32 v[100:101], v[30:31], v[84:85], v[8:9] op_sel:[0,0,0] op_sel_hi:[0,1,1] neg_hi:[0,0,1]
    v_pk_mul_f32 v[10:11], v[30:31], v[86:87] op_sel:[1,1] op_sel_hi:[1,0]
    v_pk_fma_f32 v[102:103], v[30:31], v[86:87], v[10:11] op_sel:[0,0,0] op_sel_hi:[0,1,1] neg_hi:[0,0,1]
    v_cvt_pk_f16_f32 v14, v72, v73
    v_cvt_pk_f16_f32 v15, v74, v75
    v_cvt_pk_f16_f32 v5, v76, v77
    v_cvt_pk_f16_f32 v6, v78, v79
    ds_write_addtid_b32 v14 offset:0
    ds_write_addtid_b32 v15 offset:288
    ds_write_addtid_b32 v5 offset:576
    ds_write_addtid_b32 v6 offset:864
    v_cvt_pk_f16_f32 v14, v80, v81
    v_cvt_pk_f16_f32 v15, v82, v83
    v_cvt_pk_f16_f32 v5, v84, v85
    v_cvt_pk_f16_f32 v6, v86, v87
    ds_write_addtid_b32 v14 offset:1152
    ds_write_addtid_b32 v15 offset:1440
    ds_write_addtid_b32 v5 offset:1728
    ds_write_addtid_b32 v6 offset:2016
    v_cvt_pk_f16_f32 v14, v88, v89
    v_cvt_pk_f16_f32 v15, v90, v91
    v_cvt_pk_f16_f32 v5, v92, v93
    v_cvt_pk_f16_f32 v6, v94, v95
    ds_write_addtid_b32 v14 offset:2304
    ds_write_addtid_b32 v15 offset:2592
    ds_write_addtid_b32 v5 offset:2880
    ds_write_addtid_b32 v6 offset:3168
    v_cvt_pk_f16_f32 v14, v96, v97
    v_cvt_pk_f16_f32 v15, v98, v99
    v_cvt_pk_f16_f32 v5, v100, v101
    v_cvt_pk_f16_f32 v6, v102, v103
    ds_write_addtid_b32 v14 offset:3456
    ds_write_addtid_b32 v15 offset:3744
    ds_write_addtid_b32 v5 offset:4032
    ds_write_addtid_b32 v6 offset:4320
    ds_read_b128 v[136:139], v7 offset:0
    ds_read_b128 v[140:143], v7 offset:64
    ds_read_b128 v[144:147], v7 offset:128
    ds_read_b128 v[148:151], v7 offset:192
    v_pk_mul_f32 v[8:9], v[32:33], v[72:73] op_sel:[1,1] op_sel_hi:[1,0]
    v_pk_fma_f32 v[104:105], v[32:33], v[72:73], v[8:9] op_sel:[0,0,0] op_sel_hi:[0,1,1] neg_hi:[0,0,1]
    v_pk_mul_f32 v[10:11], v[32:33], v[76:77] op_sel:[1,1] op_sel_hi:[1,0]
    v_pk_fma_f32 v[106:107], v[32:33], v[76:77], v[10:11] op_sel:[0,0,0] op_sel_hi:[0,1,1] neg_hi:[0,0,1]
    v_pk_mul_f32 v[8:9], v[32:33], v[80:81] op_sel:[1,1] op_sel_hi:[1,0]
    v_pk_fma_f32 v[108:109], v[32:33], v[80:81], v[8:9] op_sel:[0,0,0] op_sel_hi:[0,1,1] neg_hi:[0,0,1]
    v_pk_mul_f32 v[10:11], v[32:33], v[84:85] op_sel:[1,1] op_sel_hi:[1,0]
    v_pk_fma_f32 v[110:111], v[32:33], v[84:85], v[10:11] op_sel:[0,0,0] op_sel_hi:[0,1,1] neg_hi:[0,0,1]
    v_pk_mul_f32 v[8:9], v[32:33], v[88:89] op_sel:[1,1] op_sel_hi:[1,0]
    v_pk_fma_f32 v[112:113], v[32:33], v[88:89], v[8:9] op_sel:[0,0,0] op_sel_hi:[0,1,1] neg_hi:[0,0,1]
    v_pk_mul_f32 v[10:11], v[32:33], v[92:93] op_sel:[1,1] op_sel_hi:[1,0]
    v_pk_fma_f32 v[114:115], v[32:33], v[92:93], v[10:11] op_sel:[0,0,0] op_sel_hi:[0,1,1] neg_hi:[0,0,1]
    v_pk_mul_f32 v[8:9], v[32:33], v[96:97] op_sel:[1,1] op_sel_hi:[1,0]
    v_pk_fma_f32 v[116:117], v[32:33], v[96:97], v[8:9] op_sel:[0,0,0] op_sel_hi:[0,1,1] neg_hi:[0,0,1]
    v_pk_mul_f32 v[10:11], v[32:33], v[100:101] op_sel:[1,1] op_sel_hi:[1,0]
    v_pk_fma_f32 v[118:119], v[32:33], v[100:101], v[10:11] op_sel:[0,0,0] op_sel_hi:[0,1,1] neg_hi:[0,0,1]
    v_pk_mul_f32 v[8:9], v[34:35], v[72:73] op_sel:[1,1] op_sel_hi:[1,0]
    v_pk_fma_f32 v[120:121], v[34:35], v[72:73], v[8:9] op_sel:[0,0,0] op_sel_hi:[0,1,1] neg_hi:[0,0,1]
    v_pk_mul_f32 v[10:11], v[34:35], v[80:81] op_sel:[1,1] op_sel_hi:[1,0]
    v_pk_fma_f32 v[122:123], v[34:35], v[80:81], v[10:11] op_sel:[0,0,0] op_sel_hi:[0,1,1] neg_hi:[0,0,1]
    v_pk_mul_f32 v[8:9], v[34:35], v[88:89] op_sel:[1,1] op_sel_hi:[1,0]
    v_pk_fma_f32 v[124:125], v[34:35], v[88:89], v[8:9] op_sel:[0,0,0] op_sel_hi:[0,1,1] neg_hi:[0,0,1]
    v_pk_mul_f32 v[10:11], v[34:35], v[96:97] op_sel:[1,1] op_sel_hi:[1,0]
    v_pk_fma_f32 v[126:127], v[34:35], v[96:97], v[10:11] op_sel:[0,0,0] op_sel_hi:[0,1,1] neg_hi:[0,0,1]
    v_pk_mul_f32 v[8:9], v[34:35], v[104:105] op_sel:[1,1] op_sel_hi:[1,0]
    v_pk_fma_f32 v[128:129], v[34:35], v[104:105], v[8:9] op_sel:[0,0,0] op_sel_hi:[0,1,1] neg_hi:[0,0,1]
    v_pk_mul_f32 v[10:11], v[34:35], v[108:109] op_sel:[1,1] op_sel_hi:[1,0]
    v_pk_fma_f32 v[130:131], v[34:35], v[108:109], v[10:11] op_sel:[0,0,0] op_sel_hi:[0,1,1] neg_hi:[0,0,1]
    v_pk_mul_f32 v[8:9], v[34:35], v[112:113] op_sel:[1,1] op_sel_hi:[1,0]
    v_pk_fma_f32 v[132:133], v[34:35], v[112:113], v[8:9] op_sel:[0,0,0] op_sel_hi:[0,1,1] neg_hi:[0,0,1]
    v_pk_mul_f32 v[10:11], v[34:35], v[116:117] op_sel:[1,1] op_sel_hi:[1,0]
    v_pk_fma_f32 v[134:135], v[34:35], v[116:117], v[10:11] op_sel:[0,0,0] op_sel_hi:[0,1,1] neg_hi:[0,0,1]
    s_waitcnt lgkmcnt(0)
    v_mfma_f32_16x16x32_f16 v[16:19], v[136:139], v[40:43], 0
    v_cvt_pk_f16_f32 v14, v104, v105
    v_cvt_pk_f16_f32 v15, v106, v107
    v_cvt_pk_f16_f32 v5, v108, v109
    v_cvt_pk_f16_f32 v6, v110, v111
    ds_write_addtid_b32 v14 offset:0
    ds_write_addtid_b32 v15 offset:288
    ds_write_addtid_b32 v5 offset:576
    ds_write_addtid_b32 v6 offset:864
    v_mfma_f32_16x16x32_f16 v[16:19], v[140:143], v[44:47], v[16:19]
    v_cvt_pk_f16_f32 v14, v112, v113
    v_cvt_pk_f16_f32 v15, v114, v115
    v_cvt_pk_f16_f32 v5, v116, v117
    v_cvt_pk_f16_f32 v6, v118, v119
    ds_write_addtid_b32 v14 offset:1152
    ds_write_addtid_b32 v15 offset:1440
    ds_write_addtid_b32 v5 offset:1728
    ds_write_addtid_b32 v6 offset:2016
    v_mfma_f32_16x16x32_f16 v[16:19], v[144:147], v[48:51], v[16:19]
    v_cvt_pk_f16_f32 v14, v120, v121
    v_cvt_pk_f16_f32 v15, v122, v123
    v_cvt_pk_f16_f32 v5, v124, v125
    v_cvt_pk_f16_f32 v6, v126, v127
    ds_write_addtid_b32 v14 offset:2304
    ds_write_addtid_b32 v15 offset:2592
    ds_write_addtid_b32 v5 offset:2880
    ds_write_addtid_b32 v6 offset:3168
    v_mfma_f32_16x16x32_f16 v[16:19], v[148:151], v[52:55], v[16:19]
    v_cvt_pk_f16_f32 v14, v128, v129
    v_cvt_pk_f16_f32 v15, v130, v131
    v_cvt_pk_f16_f32 v5, v132, v133
    v_cvt_pk_f16_f32 v6, v134, v135
    ds_write_addtid_b32 v14 offset:3456
    ds_write_addtid_b32 v15 offset:3744
    ds_write_addtid_b32 v5 offset:4032
    ds_write_addtid_b32 v6 offset:4320
    ds_read_b128 v[136:139], v7 offset:0
    ds_read_b128 v[140:143], v7 offset:64
    ds_read_b128 v[144:147], v7 offset:128
    ds_read_b128 v[148:151], v7 offset:192
    v_pk_mul_f32 v[8:9], v[36:37], v[72:73] op_sel:[1,1] op_sel_hi:[1,0]
    v_pk_fma_f32 v[74:75], v[36:37], v[72:73], v[8:9] op_sel:[0,0,0] op_sel_hi:[0,1,1] neg_hi:[0,0,1]
    v_pk_mul_f32 v[10:11], v[36:37], v[88:89] op_sel:[1,1] op_sel_hi:[1,0]
    v_pk_fma_f32 v[76:77], v[36:37], v[88:89], v[10:11] op_sel:[0,0,0] op_sel_hi:[0,1,1] neg_hi:[0,0,1]
    v_pk_mul_f32 v[8:9], v[36:37], v[104:105] op_sel:[1,1] op_sel_hi:[1,0]
    v_pk_fma_f32 v[78:79], v[36:37], v[104:105], v[8:9] op_sel:[0,0,0] op_sel_hi:[0,1,1] neg_hi:[0,0,1]
    v_pk_mul_f32 v[10:11], v[36:37], v[112:113] op_sel:[1,1] op_sel_hi:[1,0]
    v_pk_fma_f32 v[80:81], v[36:37], v[112:113], v[10:11] op_sel:[0,0,0] op_sel_hi:[0,1,1] neg_hi:[0,0,1]
    v_pk_mul_f32 v[8:9], v[36:37], v[120:121] op_sel:[1,1] op_sel_hi:[1,0]
    v_pk_fma_f32 v[82:83], v[36:37], v[120:121], v[8:9] op_sel:[0,0,0] op_sel_hi:[0,1,1] neg_hi:[0,0,1]
    v_pk_mul_f32 v[10:11], v[36:37], v[124:125] op_sel:[1,1] op_sel_hi:[1,0]
    v_pk_fma_f32 v[84:85], v[36:37], v[124:125], v[10:11] op_sel:[0,0,0] op_sel_hi:[0,1,1] neg_hi:[0,0,1]
    v_pk_mul_f32 v[8:9], v[36:37], v[128:129] op_sel:[1,1] op_sel_hi:[1,0]
    v_pk_fma_f32 v[86:87], v[36:37], v[128:129], v[8:9] op_sel:[0,0,0] op_sel_hi:[0,1,1] neg_hi:[0,0,1]
    v_pk_mul_f32 v[10:11], v[36:37], v[132:133] op_sel:[1,1] op_sel_hi:[1,0]
    v_pk_fma_f32 v[90:91], v[36:37], v[132:133], v[10:11] op_sel:[0,0,0] op_sel_hi:[0,1,1] neg_hi:[0,0,1]
    v_pk_mul_f32 v[8:9], v[38:39], v[72:73] op_sel:[1,1] op_sel_hi:[1,0]
    v_pk_fma_f32 v[92:93], v[38:39], v[72:73], v[8:9] op_sel:[0,0,0] op_sel_hi:[0,1,1] neg_hi:[0,0,1]
    s_waitcnt lgkmcnt(0)
    v_mfma_f32_16x16x32_f16 v[20:23], v[136:139], v[40:43], 0
    v_cvt_pk_f16_f32 v14, v74, v75
    v_cvt_pk_f16_f32 v15, v76, v77
    v_cvt_pk_f16_f32 v5, v78, v79
    v_cvt_pk_f16_f32 v6, v80, v81
    ds_write_addtid_b32 v14 offset:0
    v_mfma_f32_16x16x32_f16 v[20:23], v[140:143], v[44:47], v[20:23]
    ds_write_addtid_b32 v15 offset:288
    ds_write_addtid_b32 v5 offset:576
    ds_write_addtid_b32 v6 offset:864
    v_cvt_pk_f16_f32 v14, v82, v83
    v_cvt_pk_f16_f32 v15, v84, v85
    v_mfma_f32_16x16x32_f16 v[20:23], v[144:147], v[48:51], v[20:23]
    v_cvt_pk_f16_f32 v5, v86, v87
    v_cvt_pk_f16_f32 v6, v90, v91
    ds_write_addtid_b32 v14 offset:1152
    ds_write_addtid_b32 v15 offset:1440
    ds_write_addtid_b32 v5 offset:1728
    v_mfma_f32_16x16x32_f16 v[20:23], v[148:151], v[52:55], v[20:23]
    ds_write_addtid_b32 v6 offset:2016
    v_cvt_pk_f16_f32 v14, v92, v93
    ds_write_addtid_b32 v14 offset:2304
    ds_read_b128 v[136:139], v7 offset:0
    ds_read_b128 v[140:143], v7 offset:64
    ds_read_b128 v[144:147], v7 offset:128
    ds_read_b128 v[148:151], v7 offset:192
    s_waitcnt lgkmcnt(0)
    v_mfma_f32_16x16x32_f16 v[24:27], v[136:139], v[40:43], 0
    v_mfma_f32_16x16x32_f16 v[24:27], v[140:143], v[44:47], v[24:27]
    ds_write_b128 v1, v[16:19]
    v_mfma_f32_16x16x32_f16 v[24:27], v[144:147], v[48:51], v[24:27]
    v_mfma_f32_16x16x32_f16 v[24:27], v[148:151], v[52:55], v[24:27]
    ds_write_b64 v3, v[20:21] offset:1024
    ds_write_b64 v4, v[22:23] offset:1024
    s_cmp_lg_u32 s51, 0
    s_cbranch_scc1 K1_HK1
    s_add_u32 s74, s73, 4096
    buffer_load_dwordx4 v[216:219], v188, s[68:71], s73 offen offset:0 sc1
    buffer_load_dwordx4 v[220:223], v169, s[68:71], s40 offen sc1
    buffer_load_dwordx4 v[224:227], v188, s[68:71], s73 offen offset:2048 sc1
    buffer_load_dwordx4 v[228:231], v169, s[68:71], s41 offen sc1
    buffer_load_dwordx4 v[232:235], v188, s[68:71], s74 offen offset:0 sc1
    buffer_load_dwordx4 v[236:239], v169, s[68:71], s42 offen sc1
    buffer_load_dwordx4 v[240:243], v188, s[68:71], s74 offen offset:2048 sc1
    buffer_load_dwordx4 v[244:247], v169, s[68:71], s43 offen sc1
K1_HK1:
    v_mov_b32 v136, v202
    v_mov_b32 v137, v203
    v_mov_b32 v138, v200
    v_mov_b32 v139, v201
    v_mov_b32 v140, v204
    v_mov_b32 v141, v205
    v_mov_b32 v142, v206
    s_nop 7
    ds_write_b32 v13, v24 offset:2048
    ds_write_b32 v13, v25 offset:2112
    ds_write_b32 v13, v26 offset:2176
    ds_write_b32 v13, v27 offset:2240
    s_cmp_eq_u32 s51, 0
    s_cbranch_scc1 K1_S1A
    s_lshl_b32 s75, s2, 4
    s_lshl_b32 s74, s3, 2
    s_add_u32 s75, s75, s74
    s_add_u32 s75, s75, 0x1d1fff0
    s_waitcnt vmcnt(0)
    s_mov_b64 exec, 0xff
    buffer_store_dword v192, v197, s[68:71], s75 offen sc1
    s_mov_b64 exec, -1
    s_cmp_ge_u32 s2, 196
    s_cbranch_scc1 K1_NU
    s_mul_i32 s74, s3, 3072
    s_add_u32 s74, s74, 24576
    v_lshrrev_b32 v40, 3, v2
    v_mul_u32_u24 v40, 192, v40
    v_and_b32 v41, 7, v2
    v_lshlrev_b32 v41, 4, v41
    v_add3_u32 v40, v40, v41, s74
    v_bfe_u32 v41, v2, 2, 2
    v_lshrrev_b32 v42, 5, v2
    v_lshl_add_u32 v41, v42, 2, v41
    v_mul_u32_u24 v41, 192, v41
    v_and_b32 v42, 3, v2
    v_lshl_add_u32 v41, v42, 3, v41
    v_bfe_u32 v42, v2, 4, 1
    v_lshlrev_b32 v42, 5, v42
    v_add3_u32 v41, v41, v42, s74
    v_lshlrev_b32 v42, 4, v2
    s_add_u32 s26, s27, 114688
    ds_write_b128 v40, v[216:219]
    ds_write_b128 v40, v[220:223] offset:1536
    s_waitcnt lgkmcnt(0)
    ds_read_b64_tr_b16 v[216:217], v41 offset:0
    ds_read_b64_tr_b16 v[218:219], v41 offset:1536
    ds_read_b64_tr_b16 v[220:221], v41 offset:64
    ds_read_b64_tr_b16 v[222:223], v41 offset:1600
    s_waitcnt lgkmcnt(2)
    buffer_store_dwordx4 v[216:219], v42, s[68:71], s27 offen sc1
    s_waitcnt lgkmcnt(0)
    buffer_store_dwordx4 v[220:223], v42, s[68:71], s26 offen sc1
K1_NU:
    s_branch K1_S1E
K1_S1A:
    s_mov_b32 s76, 200000
    s_lshl_b32 s36, s79, 16
    s_and_b32 s37, s79, 0xffff0000
    v_mov_b32 v184, s36
    v_mov_b32 v100, s37
    v_cndmask_b32 v184, v184, v100, s[16:17]
    s_waitcnt vmcnt(6)
    v_and_b32 v44, s47, v216
    v_and_b32 v45, s47, v217
    v_and_b32 v46, s47, v218
    v_and_b32 v47, s47, v219
    v_rcp_f32 v44, v44
    v_rcp_f32 v45, v45
    v_rcp_f32 v46, v46
    v_rcp_f32 v47, v47
    v_lshlrev_b32 v48, 16, v216
    v_lshlrev_b32 v49, 16, v217
    v_lshlrev_b32 v50, 16, v218
    v_lshlrev_b32 v51, 16, v219
    v_lshlrev_b32 v40, 16, v222
    v_and_b32 v41, s47, v222
    v_lshlrev_b32 v42, 16, v223
    v_and_b32 v43, s47, v223
    v_add_f32 v48, v48, v40
    v_add_f32 v49, v49, v41
    v_add_f32 v50, v50, v42
    v_add_f32 v51, v51, v43
    v_cvt_pk_bf16_f32 v56, v48, v49
    v_cvt_pk_bf16_f32 v57, v50, v51
    v_lshlrev_b32 v48, 16, v56
    v_and_b32 v49, s47, v56
    v_lshlrev_b32 v50, 16, v57
    v_and_b32 v51, s47, v57
    v_xor_b32 v58, s58, v220
    v_xor_b32 v59, s58, v221
    v_mul_f32 v52, v48, v44
    v_mul_f32 v53, v49, v45
    v_mul_f32 v54, v50, v46
    v_mul_f32 v55, v51, v47
    v_cvt_pk_bf16_f32 v56, v55, v54
    v_cvt_pk_bf16_f32 v57, v53, v52
    v_and_b32 v52, s47, v57
    v_lshlrev_b32 v53, 16, v57
    v_and_b32 v54, s47, v56
    v_lshlrev_b32 v55, 16, v56
    v_mul_f32 v52, v52, v184
    v_mul_f32 v53, v53, v184
    v_mul_f32 v54, v54, v184
    v_mul_f32 v55, v55, v184
    v_cvt_pk_bf16_f32 v40, v40, v52
    v_cvt_pk_bf16_f32 v41, v41, v53
    v_cvt_pk_bf16_f32 v42, v42, v54
    v_cvt_pk_bf16_f32 v43, v43, v55
    v_cmp_ne_u64 s[20:21], v[56:57], v[58:59]
    ds_write_b64 v189, v[56:57] offset:3072
    ds_write_b128 v190, v[40:43] offset:0
    s_waitcnt vmcnt(4)
    v_and_b32 v64, s47, v224
    v_and_b32 v65, s47, v225
    v_and_b32 v66, s47, v226
    v_and_b32 v67, s47, v227
    v_rcp_f32 v64, v64
    v_rcp_f32 v65, v65
    v_rcp_f32 v66, v66
    v_rcp_f32 v67, v67
    v_lshlrev_b32 v68, 16, v224
    v_lshlrev_b32 v69, 16, v225
    v_lshlrev_b32 v70, 16, v226
    v_lshlrev_b32 v71, 16, v227
    v_lshlrev_b32 v60, 16, v230
    v_and_b32 v61, s47, v230
    v_lshlrev_b32 v62, 16, v231
    v_and_b32 v63, s47, v231
    v_add_f32 v68, v68, v60
    v_add_f32 v69, v69, v61
    v_add_f32 v70, v70, v62
    v_add_f32 v71, v71, v63
    v_cvt_pk_bf16_f32 v76, v68, v69
    v_cvt_pk_bf16_f32 v77, v70, v71
    v_lshlrev_b32 v68, 16, v76
    v_and_b32 v69, s47, v76
    v_lshlrev_b32 v70, 16, v77
    v_and_b32 v71, s47, v77
    v_xor_b32 v78, s58, v228
    v_xor_b32 v79, s58, v229
    v_mul_f32 v72, v68, v64
    v_mul_f32 v73, v69, v65
    v_mul_f32 v74, v70, v66
    v_mul_f32 v75, v71, v67
    v_cvt_pk_bf16_f32 v76, v75, v74
    v_cvt_pk_bf16_f32 v77, v73, v72
    v_and_b32 v72, s47, v77
    v_lshlrev_b32 v73, 16, v77
    v_and_b32 v74, s47, v76
    v_lshlrev_b32 v75, 16, v76
    v_mul_f32 v72, v72, v184
    v_mul_f32 v73, v73, v184
    v_mul_f32 v74, v74, v184
    v_mul_f32 v75, v75, v184
    v_cvt_pk_bf16_f32 v60, v60, v72
    v_cvt_pk_bf16_f32 v61, v61, v73
    v_cvt_pk_bf16_f32 v62, v62, v74
    v_cvt_pk_bf16_f32 v63, v63, v75
    v_cmp_ne_u64 s[22:23], v[76:77], v[78:79]
    ds_write_b64 v189, v[76:77] offset:2048
    ds_write_b128 v190, v[60:63] offset:2304
    s_waitcnt vmcnt(2)
    v_and_b32 v44, s47, v232
    v_and_b32 v45, s47, v233
    v_and_b32 v46, s47, v234
    v_and_b32 v47, s47, v235
    v_rcp_f32 v44, v44
    v_rcp_f32 v45, v45
    v_rcp_f32 v46, v46
    v_rcp_f32 v47, v47
    v_lshlrev_b32 v48, 16, v232
    v_lshlrev_b32 v49, 16, v233
    v_lshlrev_b32 v50, 16, v234
    v_lshlrev_b32 v51, 16, v235
    v_lshlrev_b32 v40, 16, v238
    v_and_b32 v41, s47, v238
    v_lshlrev_b32 v42, 16, v239
    v_and_b32 v43, s47, v239
    v_add_f32 v48, v48, v40
    v_add_f32 v49, v49, v41
    v_add_f32 v50, v50, v42
    v_add_f32 v51, v51, v43
    v_cvt_pk_bf16_f32 v56, v48, v49
    v_cvt_pk_bf16_f32 v57, v50, v51
    v_lshlrev_b32 v48, 16, v56
    v_and_b32 v49, s47, v56
    v_lshlrev_b32 v50, 16, v57
    v_and_b32 v51, s47, v57
    v_xor_b32 v58, s58, v236
    v_xor_b32 v59, s58, v237
    v_mul_f32 v52, v48, v44
    v_mul_f32 v53, v49, v45
    v_mul_f32 v54, v50, v46
    v_mul_f32 v55, v51, v47
    v_cvt_pk_bf16_f32 v56, v55, v54
    v_cvt_pk_bf16_f32 v57, v53, v52
    v_and_b32 v52, s47, v57
    v_lshlrev_b32 v53, 16, v57
    v_and_b32 v54, s47, v56
    v_lshlrev_b32 v55, 16, v56
    v_mul_f32 v52, v52, v184
    v_mul_f32 v53, v53, v184
    v_mul_f32 v54, v54, v184
    v_mul_f32 v55, v55, v184
    v_cvt_pk_bf16_f32 v40, v40, v52
    v_cvt_pk_bf16_f32 v41, v41, v53
    v_cvt_pk_bf16_f32 v42, v42, v54
    v_cvt_pk_bf16_f32 v43, v43, v55
    v_cmp_ne_u64 s[24:25], v[56:57], v[58:59]
    ds_write_b64 v189, v[56:57] offset:1024
    ds_write_b128 v190, v[40:43] offset:4608
    s_waitcnt vmcnt(0)
    v_and_b32 v64, s47, v240
    v_and_b32 v65, s47, v241
    v_and_b32 v66, s47, v242
    v_and_b32 v67, s47, v243
    v_rcp_f32 v64, v64
    v_rcp_f32 v65, v65
    v_rcp_f32 v66, v66
    v_rcp_f32 v67, v67
    v_lshlrev_b32 v68, 16, v240
    v_lshlrev_b32 v69, 16, v241
    v_lshlrev_b32 v70, 16, v242
    v_lshlrev_b32 v71, 16, v243
    v_lshlrev_b32 v60, 16, v246
    v_and_b32 v61, s47, v246
    v_lshlrev_b32 v62, 16, v247
    v_and_b32 v63, s47, v247
    v_add_f32 v68, v68, v60
    v_add_f32 v69, v69, v61
    v_add_f32 v70, v70, v62
    v_add_f32 v71, v71, v63
    v_cvt_pk_bf16_f32 v76, v68, v69
    v_cvt_pk_bf16_f32 v77, v70, v71
    v_lshlrev_b32 v68, 16, v76
    v_and_b32 v69, s47, v76
    v_lshlrev_b32 v70, 16, v77
    v_and_b32 v71, s47, v77
    v_xor_b32 v78, s58, v244
    v_xor_b32 v79, s58, v245
    v_mul_f32 v72, v68, v64
    v_mul_f32 v73, v69, v65
    v_mul_f32 v74, v70, v66
    v_mul_f32 v75, v71, v67
    v_cvt_pk_bf16_f32 v76, v75, v74
    v_cvt_pk_bf16_f32 v77, v73, v72
    v_and_b32 v72, s47, v77
    v_lshlrev_b32 v73, 16, v77
    v_and_b32 v74, s47, v76
    v_lshlrev_b32 v75, 16, v76
    v_mul_f32 v72, v72, v184
    v_mul_f32 v73, v73, v184
    v_mul_f32 v74, v74, v184
    v_mul_f32 v75, v75, v184
    v_cvt_pk_bf16_f32 v60, v60, v72
    v_cvt_pk_bf16_f32 v61, v61, v73
    v_cvt_pk_bf16_f32 v62, v62, v74
    v_cvt_pk_bf16_f32 v63, v63, v75
    v_cmp_ne_u64 s[26:27], v[76:77], v[78:79]
    ds_write_b64 v189, v[76:77] offset:0
    ds_write_b128 v190, v[60:63] offset:6912
K1_SP1:
    s_or_b64 s[32:33], s[20:21], s[22:23]
    s_or_b64 s[34:35], s[24:25], s[26:27]
    s_or_b64 s[32:33], s[32:33], s[34:35]
    s_cbranch_scc0 K1_SP1D
    s_cmp_eq_u64 s[20:21], 0
    s_cbranch_scc1 K1_RP0
    s_mov_b64 exec, s[20:21]
    buffer_load_dwordx4 v[216:219], v188, s[68:71], s73 offen offset:0 sc1
    buffer_load_dwordx4 v[220:223], v169, s[68:71], s40 offen sc1
K1_RP0:
    s_cmp_eq_u64 s[22:23], 0
    s_cbranch_scc1 K1_RP1
    s_mov_b64 exec, s[22:23]
    buffer_load_dwordx4 v[224:227], v188, s[68:71], s73 offen offset:2048 sc1
    buffer_load_dwordx4 v[228:231], v169, s[68:71], s41 offen sc1
K1_RP1:
    s_cmp_eq_u64 s[24:25], 0
    s_cbranch_scc1 K1_RP2
    s_mov_b64 exec, s[24:25]
    buffer_load_dwordx4 v[232:235], v188, s[68:71], s74 offen offset:0 sc1
    buffer_load_dwordx4 v[236:239], v169, s[68:71], s42 offen sc1
K1_RP2:
    s_cmp_eq_u64 s[26:27], 0
    s_cbranch_scc1 K1_RP3
    s_mov_b64 exec, s[26:27]
    buffer_load_dwordx4 v[240:243], v188, s[68:71], s74 offen offset:2048 sc1
    buffer_load_dwordx4 v[244:247], v169, s[68:71], s43 offen sc1
K1_RP3:
    s_waitcnt vmcnt(0)
    s_cmp_eq_u64 s[20:21], 0
    s_cbranch_scc1 K1_ITr0
    s_mov_b64 exec, s[20:21]
    v_and_b32 v44, s47, v216
    v_and_b32 v45, s47, v217
    v_and_b32 v46, s47, v218
    v_and_b32 v47, s47, v219
    v_rcp_f32 v44, v44
    v_rcp_f32 v45, v45
    v_rcp_f32 v46, v46
    v_rcp_f32 v47, v47
    v_lshlrev_b32 v48, 16, v216
    v_lshlrev_b32 v49, 16, v217
    v_lshlrev_b32 v50, 16, v218
    v_lshlrev_b32 v51, 16, v219
    v_lshlrev_b32 v40, 16, v222
    v_and_b32 v41, s47, v222
    v_lshlrev_b32 v42, 16, v223
    v_and_b32 v43, s47, v223
    v_add_f32 v48, v48, v40
    v_add_f32 v49, v49, v41
    v_add_f32 v50, v50, v42
    v_add_f32 v51, v51, v43
    v_cvt_pk_bf16_f32 v56, v48, v49
    v_cvt_pk_bf16_f32 v57, v50, v51
    v_lshlrev_b32 v48, 16, v56
    v_and_b32 v49, s47, v56
    v_lshlrev_b32 v50, 16, v57
    v_and_b32 v51, s47, v57
    v_xor_b32 v58, s58, v220
    v_xor_b32 v59, s58, v221
    v_mul_f32 v52, v48, v44
    v_mul_f32 v53, v49, v45
    v_mul_f32 v54, v50, v46
    v_mul_f32 v55, v51, v47
    v_cvt_pk_bf16_f32 v56, v55, v54
    v_cvt_pk_bf16_f32 v57, v53, v52
    v_and_b32 v52, s47, v57
    v_lshlrev_b32 v53, 16, v57
    v_and_b32 v54, s47, v56
    v_lshlrev_b32 v55, 16, v56
    v_mul_f32 v52, v52, v184
    v_mul_f32 v53, v53, v184
    v_mul_f32 v54, v54, v184
    v_mul_f32 v55, v55, v184
    v_cvt_pk_bf16_f32 v40, v40, v52
    v_cvt_pk_bf16_f32 v41, v41, v53
    v_cvt_pk_bf16_f32 v42, v42, v54
    v_cvt_pk_bf16_f32 v43, v43, v55
    v_cmp_ne_u64 s[20:21], v[56:57], v[58:59]
    ds_write_b64 v189, v[56:57] offset:3072
    ds_write_b128 v190, v[40:43] offset:0
K1_ITr0:
    s_cmp_eq_u64 s[22:23], 0
    s_cbranch_scc1 K1_ITr1
    s_mov_b64 exec, s[22:23]
    v_and_b32 v64, s47, v224
    v_and_b32 v65, s47, v225
    v_and_b32 v66, s47, v226
    v_and_b32 v67, s47, v227
    v_rcp_f32 v64, v64
    v_rcp_f32 v65, v65
    v_rcp_f32 v66, v66
    v_rcp_f32 v67, v67
    v_lshlrev_b32 v68, 16, v224
    v_lshlrev_b32 v69, 16, v225
    v_lshlrev_b32 v70, 16, v226
    v_lshlrev_b32 v71, 16, v227
    v_lshlrev_b32 v60, 16, v230
    v_and_b32 v61, s47, v230
    v_lshlrev_b32 v62, 16, v231
    v_and_b32 v63, s47, v231
    v_add_f32 v68, v68, v60
    v_add_f32 v69, v69, v61
    v_add_f32 v70, v70, v62
    v_add_f32 v71, v71, v63
    v_cvt_pk_bf16_f32 v76, v68, v69
    v_cvt_pk_bf16_f32 v77, v70, v71
    v_lshlrev_b32 v68, 16, v76
    v_and_b32 v69, s47, v76
    v_lshlrev_b32 v70, 16, v77
    v_and_b32 v71, s47, v77
    v_xor_b32 v78, s58, v228
    v_xor_b32 v79, s58, v229
    v_mul_f32 v72, v68, v64
    v_mul_f32 v73, v69, v65
    v_mul_f32 v74, v70, v66
    v_mul_f32 v75, v71, v67
    v_cvt_pk_bf16_f32 v76, v75, v74
    v_cvt_pk_bf16_f32 v77, v73, v72
    v_and_b32 v72, s47, v77
    v_lshlrev_b32 v73, 16, v77
    v_and_b32 v74, s47, v76
    v_lshlrev_b32 v75, 16, v76
    v_mul_f32 v72, v72, v184
    v_mul_f32 v73, v73, v184
    v_mul_f32 v74, v74, v184
    v_mul_f32 v75, v75, v184
    v_cvt_pk_bf16_f32 v60, v60, v72
    v_cvt_pk_bf16_f32 v61, v61, v73
    v_cvt_pk_bf16_f32 v62, v62, v74
    v_cvt_pk_bf16_f32 v63, v63, v75
    v_cmp_ne_u64 s[22:23], v[76:77], v[78:79]
    ds_write_b64 v189, v[76:77] offset:2048
    ds_write_b128 v190, v[60:63] offset:2304
K1_ITr1:
    s_cmp_eq_u64 s[24:25], 0
    s_cbranch_scc1 K1_ITr2
    s_mov_b64 exec, s[24:25]
    v_and_b32 v44, s47, v232
    v_and_b32 v45, s47, v233
    v_and_b32 v46, s47, v234
    v_and_b32 v47, s47, v235
    v_rcp_f32 v44, v44
    v_rcp_f32 v45, v45
    v_rcp_f32 v46, v46
    v_rcp_f32 v47, v47
    v_lshlrev_b32 v48, 16, v232
    v_lshlrev_b32 v49, 16, v233
    v_lshlrev_b32 v50, 16, v234
    v_lshlrev_b32 v51, 16, v235
    v_lshlrev_b32 v40, 16, v238
    v_and_b32 v41, s47, v238
    v_lshlrev_b32 v42, 16, v239
    v_and_b32 v43, s47, v239
    v_add_f32 v48, v48, v40
    v_add_f32 v49, v49, v41
    v_add_f32 v50, v50, v42
    v_add_f32 v51, v51, v43
    v_cvt_pk_bf16_f32 v56, v48, v49
    v_cvt_pk_bf16_f32 v57, v50, v51
    v_lshlrev_b32 v48, 16, v56
    v_and_b32 v49, s47, v56
    v_lshlrev_b32 v50, 16, v57
    v_and_b32 v51, s47, v57
    v_xor_b32 v58, s58, v236
    v_xor_b32 v59, s58, v237
    v_mul_f32 v52, v48, v44
    v_mul_f32 v53, v49, v45
    v_mul_f32 v54, v50, v46
    v_mul_f32 v55, v51, v47
    v_cvt_pk_bf16_f32 v56, v55, v54
    v_cvt_pk_bf16_f32 v57, v53, v52
    v_and_b32 v52, s47, v57
    v_lshlrev_b32 v53, 16, v57
    v_and_b32 v54, s47, v56
    v_lshlrev_b32 v55, 16, v56
    v_mul_f32 v52, v52, v184
    v_mul_f32 v53, v53, v184
    v_mul_f32 v54, v54, v184
    v_mul_f32 v55, v55, v184
    v_cvt_pk_bf16_f32 v40, v40, v52
    v_cvt_pk_bf16_f32 v41, v41, v53
    v_cvt_pk_bf16_f32 v42, v42, v54
    v_cvt_pk_bf16_f32 v43, v43, v55
    v_cmp_ne_u64 s[24:25], v[56:57], v[58:59]
    ds_write_b64 v189, v[56:57] offset:1024
    ds_write_b128 v190, v[40:43] offset:4608
K1_ITr2:
    s_cmp_eq_u64 s[26:27], 0
    s_cbranch_scc1 K1_ITr3
    s_mov_b64 exec, s[26:27]
    v_and_b32 v64, s47, v240
    v_and_b32 v65, s47, v241
    v_and_b32 v66, s47, v242
    v_and_b32 v67, s47, v243
    v_rcp_f32 v64, v64
    v_rcp_f32 v65, v65
    v_rcp_f32 v66, v66
    v_rcp_f32 v67, v67
    v_lshlrev_b32 v68, 16, v240
    v_lshlrev_b32 v69, 16, v241
    v_lshlrev_b32 v70, 16, v242
    v_lshlrev_b32 v71, 16, v243
    v_lshlrev_b32 v60, 16, v246
    v_and_b32 v61, s47, v246
    v_lshlrev_b32 v62, 16, v247
    v_and_b32 v63, s47, v247
    v_add_f32 v68, v68, v60
    v_add_f32 v69, v69, v61
    v_add_f32 v70, v70, v62
    v_add_f32 v71, v71, v63
    v_cvt_pk_bf16_f32 v76, v68, v69
    v_cvt_pk_bf16_f32 v77, v70, v71
    v_lshlrev_b32 v68, 16, v76
    v_and_b32 v69, s47, v76
    v_lshlrev_b32 v70, 16, v77
    v_and_b32 v71, s47, v77
    v_xor_b32 v78, s58, v244
    v_xor_b32 v79, s58, v245
    v_mul_f32 v72, v68, v64
    v_mul_f32 v73, v69, v65
    v_mul_f32 v74, v70, v66
    v_mul_f32 v75, v71, v67
    v_cvt_pk_bf16_f32 v76, v75, v74
    v_cvt_pk_bf16_f32 v77, v73, v72
    v_and_b32 v72, s47, v77
    v_lshlrev_b32 v73, 16, v77
    v_and_b32 v74, s47, v76
    v_lshlrev_b32 v75, 16, v76
    v_mul_f32 v72, v72, v184
    v_mul_f32 v73, v73, v184
    v_mul_f32 v74, v74, v184
    v_mul_f32 v75, v75, v184
    v_cvt_pk_bf16_f32 v60, v60, v72
    v_cvt_pk_bf16_f32 v61, v61, v73
    v_cvt_pk_bf16_f32 v62, v62, v74
    v_cvt_pk_bf16_f32 v63, v63, v75
    v_cmp_ne_u64 s[26:27], v[76:77], v[78:79]
    ds_write_b64 v189, v[76:77] offset:0
    ds_write_b128 v190, v[60:63] offset:6912
K1_ITr3:
    s_sub_u32 s76, s76, 1
    s_cbranch_scc0 K1_SP1
K1_SP1D:
    s_mov_b64 exec, -1
K1_S1E:
    v_mov_b32 v56, 0
    v_mov_b32 v57, 0
    v_mov_b32 v58, 0
    v_mov_b32 v59, 0
    v_cmp_gt_u32 vcc, 96, v0
    s_lshr_b32 s17, s2, 5
    s_lshl_b32 s17, s17, 9
    s_lshl_b32 s16, s3, 6
    s_add_u32 s17, s17, s16
    v_lshrrev_b32 v107, 2, v2
    v_mul_u32_u24 v107, 3584, v107
    v_and_b32 v15, 3, v2
    v_lshl_add_u32 v132, v15, 4, v107
    v_lshlrev_b32 v15, 4, v2
    v_lshlrev_b32 v143, 7, v2
    v_lshlrev_b32 v133, 6, v2
    s_lshr_b32 s17, s2, 5
    s_lshl_b32 s17, s17, 3
    s_add_u32 s17, s17, s3
    s_mul_i32 s17, s17, 28672
    s_add_u32 s17, s17, 0x1800000
    s_bfe_u32 s18, s2, 0x20003
    s_mov_b32 s18, 0
    s_add_u32 s40, s18, 0
    s_and_b32 s40, s40, 3
    s_mul_i32 s40, s40, 7168
    s_add_u32 s40, s40, s17
    s_add_u32 s41, s18, 1
    s_and_b32 s41, s41, 3
    s_mul_i32 s41, s41, 7168
    s_add_u32 s41, s41, s17
    s_add_u32 s42, s18, 2
    s_and_b32 s42, s42, 3
    s_mul_i32 s42, s42, 7168
    s_add_u32 s42, s42, s17
    s_add_u32 s43, s18, 3
    s_and_b32 s43, s43, 3
    s_mul_i32 s43, s43, 7168
    s_add_u32 s43, s43, s17
    v_lshlrev_b32 v132, 2, v2
    s_lshl_b32 s12, s2, 8
    s_lshr_b32 s18, s3, 1
    s_lshl_b32 s18, s18, 5
    s_add_u32 s12, s12, s18
    s_add_u32 s12, s12, 0x1d40000
    s_min_u32 s18, s3, 6
    s_lshl_b32 s18, s18, 9
    s_mov_b32 s15, s14
    s_add_u32 s13, s73, s18
    s_add_u32 s13, s13, 0x20000
    s_lshr_b32 s16, s2, 5
    s_mul_i32 s16, s16, 229376
    s_bfe_u32 s18, s2, 0x20003
    s_lshl_b32 s18, s18, 3
    s_add_u32 s18, s18, s3
    s_mul_i32 s18, s18, 7168
    s_add_u32 s16, s16, s18
    s_add_u32 s16, s16, 0x1988000
    s_mov_b32 s36, 0x3f800000
    s_mov_b32 s37, 0x00003f80
    s_waitcnt lgkmcnt(0)
    s_barrier
    ds_read_b32 v80, v186 offset:0
    ds_read_b32 v81, v186 offset:4608
    ds_read_b32 v82, v186 offset:9216
    ds_read_b32 v83, v186 offset:13824
    ds_read_b32 v84, v186 offset:1024
    ds_read_b32 v85, v186 offset:5632
    ds_read_b32 v86, v186 offset:10240
    ds_read_b32 v87, v186 offset:14848
    ds_read_b32 v88, v186 offset:2048
    ds_read_b32 v89, v186 offset:6656
    ds_read_b32 v90, v186 offset:11264
    ds_read_b32 v91, v186 offset:15872
    ds_read_b128 v[72:75], v191
    ds_read_b128 v[76:79], v191 offset:16
    ds_read_b128 v[4:7], v142
    ds_read_b128 v[8:11], v142 offset:64
    s_waitcnt lgkmcnt(12)
    v_add_f32 v80, v80, v81
    v_add_f32 v82, v82, v83
    v_add_f32 v80, v80, v82
    v_mul_f32 v80, v80, v12
    ds_write_b32 v185, v80 offset:0
    s_waitcnt lgkmcnt(9)
    v_add_f32 v84, v84, v85
    v_add_f32 v86, v86, v87
    v_add_f32 v84, v84, v86
    v_mul_f32 v84, v84, v12
    ds_write_b32 v185, v84 offset:1024
    s_waitcnt lgkmcnt(6)
    v_add_f32 v88, v88, v89
    v_add_f32 v90, v90, v91
    v_add_f32 v88, v88, v90
    v_mul_f32 v88, v88, v12
    ds_write_b32 v185, v88 offset:2048
    s_waitcnt lgkmcnt(5)
    v_alignbit_b32 v44, v73, v72, 16
    v_alignbit_b32 v45, v74, v73, 16
    v_alignbit_b32 v46, v75, v74, 16
    v_alignbit_b32 v47, v76, v75, 16
    ds_write_b128 v191, v[44:47] offset:4160
    v_mov_b32 v48, v73
    v_mov_b32 v49, v74
    v_mov_b32 v50, v75
    v_mov_b32 v51, v76
    ds_write_b128 v191, v[48:51] offset:8320
    s_waitcnt lgkmcnt(2)
    s_barrier
    ds_read_b32 v80, v176
    ds_read_b32 v81, v177
    ds_read_b32 v82, v178
    ds_read_b32 v83, v179
    ds_read_b32 v84, v180
    ds_read_b32 v85, v181
    ds_read_b32 v86, v182
    ds_read_b32 v87, v183
    s_and_saveexec_b64 s[34:35], vcc
    ds_write_b128 v208, v[56:59]
    s_mov_b64 exec, s[34:35]
    v_alignbit_b32 v52, v74, v73, 16
    v_alignbit_b32 v53, v75, v74, 16
    v_alignbit_b32 v54, v76, v75, 16
    v_alignbit_b32 v55, v77, v76, 16
    ds_write_b128 v191, v[52:55] offset:12480
    ds_write_b128 v191, v[74:77] offset:16640
    v_alignbit_b32 v44, v75, v74, 16
    v_alignbit_b32 v45, v76, v75, 16
    v_alignbit_b32 v46, v77, v76, 16
    v_alignbit_b32 v47, v78, v77, 16
    ds_write_b128 v191, v[44:47] offset:20800
    v_mov_b32 v48, v75
    v_mov_b32 v49, v76
    v_mov_b32 v50, v77
    v_mov_b32 v51, v78
    ds_write_b128 v191, v[48:51] offset:24960
    v_alignbit_b32 v52, v76, v75, 16
    v_alignbit_b32 v53, v77, v76, 16
    v_alignbit_b32 v54, v78, v77, 16
    v_alignbit_b32 v55, v79, v78, 16
    ds_write_b128 v191, v[52:55] offset:29120
    s_waitcnt lgkmcnt(6)
    v_cvt_pk_bf16_f32 v60, v80, v81
    v_cvt_pk_bf16_f32 v61, v82, v83
    v_cvt_pk_bf16_f32 v62, v84, v85
    v_cvt_pk_bf16_f32 v63, v86, v87
    ds_write_b128 v207, v[60:63] offset:1536
    s_waitcnt lgkmcnt(0)
    s_barrier
    ds_read_b128 v[48:51], v137 offset:1824
    ds_read_b128 v[52:55], v136 offset:3296
    ds_read_b128 v[56:59], v136 offset:3264
    ds_read_b128 v[60:63], v137 offset:3360
    ds_read_b128 v[64:67], v137 offset:4896
    ds_read_b128 v[68:71], v137 offset:6432
    ds_read_b128 v[72:75], v136 offset:2272
    ds_read_b128 v[76:79], v136 offset:2240
    ds_read_b128 v[80:83], v136 offset:1248
    ds_read_b128 v[84:87], v136 offset:1216
    ds_read_b128 v[88:91], v136 offset:224
    ds_read_b128 v[92:95], v136 offset:192
    s_waitcnt lgkmcnt(10)
    v_mfma_f32_16x16x32_bf16 v[16:19], v[52:55], v[48:51], 0
    ds_read_b128 v[96:99], v137 offset:1728
    ds_read_b128 v[100:103], v136 offset:3232
    s_waitcnt lgkmcnt(11)
    v_mfma_f32_16x16x32_bf16 v[20:23], v[56:59], v[48:51], 0
    ds_read_b128 v[104:107], v136 offset:3200
    s_waitcnt lgkmcnt(11)
    v_mfma_f32_16x16x32_bf16 v[24:27], v[52:55], v[60:63], 0
    ds_read_b128 v[108:111], v137 offset:3264
    v_mfma_f32_16x16x32_bf16 v[28:31], v[56:59], v[60:63], 0
    s_waitcnt lgkmcnt(11)
    v_mfma_f32_16x16x32_bf16 v[32:35], v[52:55], v[64:67], 0
    ds_read_b128 v[112:115], v137 offset:4800
    v_mfma_f32_16x16x32_bf16 v[36:39], v[56:59], v[64:67], 0
    s_waitcnt lgkmcnt(11)
    v_mfma_f32_16x16x32_bf16 v[40:43], v[52:55], v[68:71], 0
    ds_read_b128 v[116:119], v137 offset:6336
    v_mfma_f32_16x16x32_bf16 v[44:47], v[56:59], v[68:71], 0
    s_mov_b64 exec, 0x7f
    buffer_load_dword v134, v132, s[68:71], s12 offen sc1
    s_mov_b32 exec_lo, -1
    buffer_load_dwordx4 v[128:131], v15, s[68:71], s13 offen sc1
    s_mov_b64 exec, -1
    s_waitcnt lgkmcnt(11)
    v_mfma_f32_16x16x32_bf16 v[24:27], v[72:75], v[48:51], v[24:27]
    ds_read_b128 v[120:123], v136 offset:2208
    s_waitcnt lgkmcnt(11)
    v_mfma_f32_16x16x32_bf16 v[28:31], v[76:79], v[48:51], v[28:31]
    ds_read_b128 v[124:127], v136 offset:2176
    v_mfma_f32_16x16x32_bf16 v[32:35], v[72:75], v[60:63], v[32:35]
    v_mfma_f32_16x16x32_bf16 v[36:39], v[76:79], v[60:63], v[36:39]
    v_mfma_f32_16x16x32_bf16 v[40:43], v[72:75], v[64:67], v[40:43]
    v_mfma_f32_16x16x32_bf16 v[44:47], v[76:79], v[64:67], v[44:47]
    s_waitcnt lgkmcnt(11)
    v_mfma_f32_16x16x32_bf16 v[32:35], v[80:83], v[48:51], v[32:35]
    ds_read_b128 v[52:55], v136 offset:1184
    s_waitcnt lgkmcnt(11)
    v_mfma_f32_16x16x32_bf16 v[36:39], v[84:87], v[48:51], v[36:39]
    ds_read_b128 v[56:59], v136 offset:1152
    v_mfma_f32_16x16x32_bf16 v[40:43], v[80:83], v[60:63], v[40:43]
    v_mfma_f32_16x16x32_bf16 v[44:47], v[84:87], v[60:63], v[44:47]
    s_waitcnt lgkmcnt(11)
    v_mfma_f32_16x16x32_bf16 v[40:43], v[88:91], v[48:51], v[40:43]
    ds_read_b128 v[68:71], v136 offset:160
    s_waitcnt lgkmcnt(11)
    v_mfma_f32_16x16x32_bf16 v[44:47], v[92:95], v[48:51], v[44:47]
    ds_read_b128 v[72:75], v136 offset:128
    s_waitcnt lgkmcnt(10)
    v_mfma_f32_16x16x32_bf16 v[16:19], v[100:103], v[96:99], v[16:19]
    ds_read_b128 v[76:79], v137 offset:1632
    ds_read_b128 v[64:67], v136 offset:3168
    s_waitcnt lgkmcnt(11)
    v_mfma_f32_16x16x32_bf16 v[20:23], v[104:107], v[96:99], v[20:23]
    ds_read_b128 v[80:83], v136 offset:3136
    s_waitcnt lgkmcnt(11)
    v_mfma_f32_16x16x32_bf16 v[24:27], v[100:103], v[108:111], v[24:27]
    ds_read_b128 v[84:87], v137 offset:3168
    v_mfma_f32_16x16x32_bf16 v[28:31], v[104:107], v[108:111], v[28:31]
    s_mov_b32 s76, 200000
    s_mov_b64 exec, 0x7f
    s_waitcnt vmcnt(0)
K2_WP1:
    v_cmp_ne_u32 vcc, s14, v134
    s_cmp_eq_u64 vcc, 0
    s_cbranch_scc1 K2_WG1
    buffer_load_dword v134, v132, s[68:71], s12 offen sc1
    s_waitcnt vmcnt(0)
    s_sub_u32 s76, s76, 1
    s_cbranch_scc0 K2_WP1
K2_WG1:
    s_mov_b64 exec, -1
    buffer_load_dwordx4 v[144:147], v15, s[68:71], s40 offen offset:0
    s_waitcnt lgkmcnt(11)
    v_mfma_f32_16x16x32_bf16 v[32:35], v[100:103], v[112:115], v[32:35]
    ds_read_b128 v[60:63], v137 offset:4704
    v_mfma_f32_16x16x32_bf16 v[36:39], v[104:107], v[112:115], v[36:39]
    buffer_load_dwordx4 v[148:151], v15, s[68:71], s40 offen offset:1024
    s_waitcnt lgkmcnt(11)
    v_mfma_f32_16x16x32_bf16 v[40:43], v[100:103], v[116:119], v[40:43]
    ds_read_b128 v[88:91], v137 offset:6240
    v_mfma_f32_16x16x32_bf16 v[44:47], v[104:107], v[116:119], v[44:47]
    buffer_load_dwordx4 v[152:155], v15, s[68:71], s40 offen offset:2048
    s_waitcnt lgkmcnt(11)
    v_mfma_f32_16x16x32_bf16 v[24:27], v[120:123], v[96:99], v[24:27]
    ds_read_b128 v[92:95], v136 offset:2144
    s_waitcnt lgkmcnt(11)
    v_mfma_f32_16x16x32_bf16 v[28:31], v[124:127], v[96:99], v[28:31]
    ds_read_b128 v[48:51], v136 offset:2112
    buffer_load_dwordx4 v[156:159], v15, s[68:71], s40 offen offset:3072
    s_add_u32 s40, s40, 4096
    v_mfma_f32_16x16x32_bf16 v[32:35], v[120:123], v[108:111], v[32:35]
    v_mfma_f32_16x16x32_bf16 v[36:39], v[124:127], v[108:111], v[36:39]
    buffer_load_dwordx4 v[160:163], v15, s[68:71], s40 offen offset:0
    v_mfma_f32_16x16x32_bf16 v[40:43], v[120:123], v[112:115], v[40:43]
    v_mfma_f32_16x16x32_bf16 v[44:47], v[124:127], v[112:115], v[44:47]
    buffer_load_dwordx4 v[164:167], v15, s[68:71], s40 offen offset:1024
    s_waitcnt lgkmcnt(11)
    v_mfma_f32_16x16x32_bf16 v[32:35], v[52:55], v[96:99], v[32:35]
    ds_read_b128 v[100:103], v136 offset:1120
    s_waitcnt lgkmcnt(11)
    v_mfma_f32_16x16x32_bf16 v[36:39], v[56:59], v[96:99], v[36:39]
    ds_read_b128 v[104:107], v136 offset:1088
    buffer_load_dwordx4 v[168:171], v15, s[68:71], s40 offen offset:2048
    v_mfma_f32_16x16x32_bf16 v[40:43], v[52:55], v[108:111], v[40:43]
    v_mfma_f32_16x16x32_bf16 v[44:47], v[56:59], v[108:111], v[44:47]
    buffer_load_dwordx4 v[172:175], v15, s[68:71], s41 offen offset:0
    s_waitcnt lgkmcnt(11)
    v_mfma_f32_16x16x32_bf16 v[40:43], v[68:71], v[96:99], v[40:43]
    ds_read_b128 v[116:119], v136 offset:96
    s_waitcnt lgkmcnt(11)
    v_mfma_f32_16x16x32_bf16 v[44:47], v[72:75], v[96:99], v[44:47]
    ds_read_b128 v[120:123], v136 offset:64
    buffer_load_dwordx4 v[176:179], v15, s[68:71], s41 offen offset:1024
    s_waitcnt lgkmcnt(10)
    v_mfma_f32_16x16x32_bf16 v[16:19], v[64:67], v[76:79], v[16:19]
    ds_read_b128 v[124:127], v137 offset:1536
    ds_read_b128 v[112:115], v136 offset:3104
    s_waitcnt lgkmcnt(11)
    v_mfma_f32_16x16x32_bf16 v[20:23], v[80:83], v[76:79], v[20:23]
    ds_read_b128 v[52:55], v136 offset:3072
    buffer_load_dwordx4 v[180:183], v15, s[68:71], s41 offen offset:2048
    s_waitcnt lgkmcnt(11)
    v_mfma_f32_16x16x32_bf16 v[24:27], v[64:67], v[84:87], v[24:27]
    ds_read_b128 v[56:59], v137 offset:3072
    v_mfma_f32_16x16x32_bf16 v[28:31], v[80:83], v[84:87], v[28:31]
    buffer_load_dwordx4 v[184:187], v15, s[68:71], s41 offen offset:3072
    s_add_u32 s41, s41, 4096
    s_waitcnt lgkmcnt(11)
    v_mfma_f32_16x16x32_bf16 v[32:35], v[64:67], v[60:63], v[32:35]
    ds_read_b128 v[108:111], v137 offset:4608
    v_mfma_f32_16x16x32_bf16 v[36:39], v[80:83], v[60:63], v[36:39]
    buffer_load_dwordx4 v[188:191], v15, s[68:71], s41 offen offset:0
    s_waitcnt lgkmcnt(11)
    v_mfma_f32_16x16x32_bf16 v[40:43], v[64:67], v[88:91], v[40:43]
    ds_read_b128 v[68:71], v137 offset:6144
    v_mfma_f32_16x16x32_bf16 v[44:47], v[80:83], v[88:91], v[44:47]
    buffer_load_dwordx4 v[192:195], v15, s[68:71], s41 offen offset:1024
    s_waitcnt lgkmcnt(11)
    v_mfma_f32_16x16x32_bf16 v[24:27], v[92:95], v[76:79], v[24:27]
    ds_read_b128 v[72:75], v136 offset:2080
    s_waitcnt lgkmcnt(11)
    v_mfma_f32_16x16x32_bf16 v[28:31], v[48:51], v[76:79], v[28:31]
    ds_read_b128 v[96:99], v136 offset:2048
    buffer_load_dwordx4 v[196:199], v15, s[68:71], s41 offen offset:2048
    v_mfma_f32_16x16x32_bf16 v[32:35], v[92:95], v[84:87], v[32:35]
    v_mfma_f32_16x16x32_bf16 v[36:39], v[48:51], v[84:87], v[36:39]
    buffer_load_dwordx4 v[200:203], v15, s[68:71], s42 offen offset:0
    v_mfma_f32_16x16x32_bf16 v[40:43], v[92:95], v[60:63], v[40:43]
    v_mfma_f32_16x16x32_bf16 v[44:47], v[48:51], v[60:63], v[44:47]
    buffer_load_dwordx4 v[204:207], v15, s[68:71], s42 offen offset:1024
    s_waitcnt lgkmcnt(11)
    v_mfma_f32_16x16x32_bf16 v[32:35], v[100:103], v[76:79], v[32:35]
    ds_read_b128 v[64:67], v136 offset:1056
    s_waitcnt lgkmcnt(11)
    v_mfma_f32_16x16x32_bf16 v[36:39], v[104:107], v[76:79], v[36:39]
    ds_read_b128 v[80:83], v136 offset:1024
    buffer_load_dwordx4 v[208:211], v15, s[68:71], s42 offen offset:2048
    v_mfma_f32_16x16x32_bf16 v[40:43], v[100:103], v[84:87], v[40:43]
    v_mfma_f32_16x16x32_bf16 v[44:47], v[104:107], v[84:87], v[44:47]
    buffer_load_dwordx4 v[212:215], v15, s[68:71], s42 offen offset:3072
    s_add_u32 s42, s42, 4096
    s_waitcnt lgkmcnt(11)
    v_mfma_f32_16x16x32_bf16 v[40:43], v[116:119], v[76:79], v[40:43]
    ds_read_b128 v[88:91], v136 offset:32
    s_waitcnt lgkmcnt(11)
    v_mfma_f32_16x16x32_bf16 v[44:47], v[120:123], v[76:79], v[44:47]
    ds_read_b128 v[92:95], v136 offset:0
    buffer_load_dwordx4 v[216:219], v15, s[68:71], s42 offen offset:0
    s_waitcnt lgkmcnt(10)
    v_mfma_f32_16x16x32_bf16 v[16:19], v[112:115], v[124:127], v[16:19]
    s_waitcnt lgkmcnt(9)
    v_mfma_f32_16x16x32_bf16 v[20:23], v[52:55], v[124:127], v[20:23]
    buffer_load_dwordx4 v[220:223], v15, s[68:71], s42 offen offset:1024
    s_waitcnt lgkmcnt(8)
    v_mfma_f32_16x16x32_bf16 v[24:27], v[112:115], v[56:59], v[24:27]
    v_mfma_f32_16x16x32_bf16 v[28:31], v[52:55], v[56:59], v[28:31]
    s_waitcnt lgkmcnt(7)
    v_mfma_f32_16x16x32_bf16 v[32:35], v[112:115], v[108:111], v[32:35]
    v_mfma_f32_16x16x32_bf16 v[36:39], v[52:55], v[108:111], v[36:39]
    s_waitcnt lgkmcnt(6)
    v_mfma_f32_16x16x32_bf16 v[40:43], v[112:115], v[68:71], v[40:43]
    v_mfma_f32_16x16x32_bf16 v[44:47], v[52:55], v[68:71], v[44:47]
    s_waitcnt lgkmcnt(5)
    v_mfma_f32_16x16x32_bf16 v[24:27], v[72:75], v[124:127], v[24:27]
    s_waitcnt lgkmcnt(4)
    v_mfma_f32_16x16x32_bf16 v[28:31], v[96:99], v[124:127], v[28:31]
    v_mfma_f32_16x16x32_bf16 v[32:35], v[72:75], v[56:59], v[32:35]
    v_mfma_f32_16x16x32_bf16 v[36:39], v[96:99], v[56:59], v[36:39]
    v_mfma_f32_16x16x32_bf16 v[40:43], v[72:75], v[108:111], v[40:43]
    v_mfma_f32_16x16x32_bf16 v[44:47], v[96:99], v[108:111], v[44:47]
    s_waitcnt lgkmcnt(3)
    v_mfma_f32_16x16x32_bf16 v[32:35], v[64:67], v[124:127], v[32:35]
    s_waitcnt lgkmcnt(2)
    v_mfma_f32_16x16x32_bf16 v[36:39], v[80:83], v[124:127], v[36:39]
    v_mfma_f32_16x16x32_bf16 v[40:43], v[64:67], v[56:59], v[40:43]
    v_mfma_f32_16x16x32_bf16 v[44:47], v[80:83], v[56:59], v[44:47]
    s_waitcnt lgkmcnt(1)
    v_mfma_f32_16x16x32_bf16 v[40:43], v[88:91], v[124:127], v[40:43]
    s_waitcnt lgkmcnt(0)
    v_mfma_f32_16x16x32_bf16 v[44:47], v[92:95], v[124:127], v[44:47]
    s_mov_b32 s76, 200000
    s_waitcnt vmcnt(20)
    s_mov_b32 exec_hi, 0
K2_FP1:
    v_cmp_ne_u64 vcc, s[14:15], v[128:129]
    v_cmp_ne_u64 s[34:35], s[14:15], v[130:131]
    s_or_b64 vcc, vcc, s[34:35]
    s_cbranch_scc0 K2_FG1
    s_mov_b64 exec, vcc
    buffer_load_dwordx4 v[128:131], v15, s[68:71], s13 offen sc1
    s_waitcnt vmcnt(0)
    s_sub_u32 s76, s76, 1
    s_cbranch_scc0 K2_FP1
K2_FG1:
    s_mov_b64 exec, -1
    s_nop 3
    s_cmp_lg_u32 s6, 0
    s_cbranch_scc1 K2_R1
    ds_write_b128 v140, v[16:19] offset:0
    ds_write_b128 v140, v[20:23] offset:1024
    ds_write_b128 v140, v[24:27] offset:6144
    ds_write_b128 v140, v[28:31] offset:7168
    ds_write_b128 v140, v[32:35] offset:12288
    ds_write_b128 v140, v[36:39] offset:13312
    s_waitcnt lgkmcnt(0)
    s_barrier
    ds_read_b128 v[64:67], v140 offset:18432
    ds_read_b128 v[68:71], v140 offset:19456
    ds_read_b128 v[72:75], v140 offset:20480
    ds_read_b128 v[76:79], v140 offset:21504
    ds_read_b128 v[80:83], v140 offset:22528
    ds_read_b128 v[84:87], v140 offset:23552
    s_waitcnt lgkmcnt(4)
    v_add_f32 v16, v40, v64
    v_add_f32 v17, v41, v65
    v_add_f32 v18, v42, v66
    v_add_f32 v19, v43, v67
    v_add_f32 v20, v44, v68
    v_add_f32 v21, v45, v69
    v_add_f32 v22, v46, v70
    v_add_f32 v23, v47, v71
    s_waitcnt lgkmcnt(2)
    v_add_f32 v16, v16, v72
    v_add_f32 v17, v17, v73
    v_add_f32 v18, v18, v74
    v_add_f32 v19, v19, v75
    v_add_f32 v20, v20, v76
    v_add_f32 v21, v21, v77
    v_add_f32 v22, v22, v78
    v_add_f32 v23, v23, v79
    s_waitcnt lgkmcnt(0)
    v_add_f32 v16, v16, v80
    v_add_f32 v17, v17, v81
    v_add_f32 v18, v18, v82
    v_add_f32 v19, v19, v83
    v_add_f32 v20, v20, v84
    v_add_f32 v21, v21, v85
    v_add_f32 v22, v22, v86
    v_add_f32 v23, v23, v87
    s_branch K2_EPI
K2_R1:
    s_cmp_lg_u32 s6, 1
    s_cbranch_scc1 K2_R2
    ds_write_b128 v140, v[16:19] offset:2048
    ds_write_b128 v140, v[20:23] offset:3072
    ds_write_b128 v140, v[24:27] offset:8192
    ds_write_b128 v140, v[28:31] offset:9216
    ds_write_b128 v140, v[40:43] offset:18432
    ds_write_b128 v140, v[44:47] offset:19456
    s_waitcnt lgkmcnt(0)
    s_barrier
    ds_read_b128 v[64:67], v140 offset:12288
    ds_read_b128 v[68:71], v140 offset:13312
    ds_read_b128 v[72:75], v140 offset:14336
    ds_read_b128 v[76:79], v140 offset:15360
    ds_read_b128 v[80:83], v140 offset:16384
    ds_read_b128 v[84:87], v140 offset:17408
    s_waitcnt lgkmcnt(4)
    v_add_f32 v16, v32, v64
    v_add_f32 v17, v33, v65
    v_add_f32 v18, v34, v66
    v_add_f32 v19, v35, v67
    v_add_f32 v20, v36, v68
    v_add_f32 v21, v37, v69
    v_add_f32 v22, v38, v70
    v_add_f32 v23, v39, v71
    s_waitcnt lgkmcnt(2)
    v_add_f32 v16, v16, v72
    v_add_f32 v17, v17, v73
    v_add_f32 v18, v18, v74
    v_add_f32 v19, v19, v75
    v_add_f32 v20, v20, v76
    v_add_f32 v21, v21, v77
    v_add_f32 v22, v22, v78
    v_add_f32 v23, v23, v79
    s_waitcnt lgkmcnt(0)
    v_add_f32 v16, v16, v80
    v_add_f32 v17, v17, v81
    v_add_f32 v18, v18, v82
    v_add_f32 v19, v19, v83
    v_add_f32 v20, v20, v84
    v_add_f32 v21, v21, v85
    v_add_f32 v22, v22, v86
    v_add_f32 v23, v23, v87
    s_branch K2_EPI
K2_R2:
    s_cmp_lg_u32 s6, 2
    s_cbranch_scc1 K2_R3
    ds_write_b128 v140, v[16:19] offset:4096
    ds_write_b128 v140, v[20:23] offset:5120
    ds_write_b128 v140, v[32:35] offset:14336
    ds_write_b128 v140, v[36:39] offset:15360
    ds_write_b128 v140, v[40:43] offset:20480
    ds_write_b128 v140, v[44:47] offset:21504
    s_waitcnt lgkmcnt(0)
    s_barrier
    ds_read_b128 v[64:67], v140 offset:6144
    ds_read_b128 v[68:71], v140 offset:7168
    ds_read_b128 v[72:75], v140 offset:8192
    ds_read_b128 v[76:79], v140 offset:9216
    ds_read_b128 v[80:83], v140 offset:10240
    ds_read_b128 v[84:87], v140 offset:11264
    s_waitcnt lgkmcnt(4)
    v_add_f32 v16, v24, v64
    v_add_f32 v17, v25, v65
    v_add_f32 v18, v26, v66
    v_add_f32 v19, v27, v67
    v_add_f32 v20, v28, v68
    v_add_f32 v21, v29, v69
    v_add_f32 v22, v30, v70
    v_add_f32 v23, v31, v71
    s_waitcnt lgkmcnt(2)
    v_add_f32 v16, v16, v72
    v_add_f32 v17, v17, v73
    v_add_f32 v18, v18, v74
    v_add_f32 v19, v19, v75
    v_add_f32 v20, v20, v76
    v_add_f32 v21, v21, v77
    v_add_f32 v22, v22, v78
    v_add_f32 v23, v23, v79
    s_waitcnt lgkmcnt(0)
    v_add_f32 v16, v16, v80
    v_add_f32 v17, v17, v81
    v_add_f32 v18, v18, v82
    v_add_f32 v19, v19, v83
    v_add_f32 v20, v20, v84
    v_add_f32 v21, v21, v85
    v_add_f32 v22, v22, v86
    v_add_f32 v23, v23, v87
    s_branch K2_EPI
K2_R3:
    ds_write_b128 v140, v[24:27] offset:10240
    ds_write_b128 v140, v[28:31] offset:11264
    ds_write_b128 v140, v[32:35] offset:16384
    ds_write_b128 v140, v[36:39] offset:17408
    ds_write_b128 v140, v[40:43] offset:22528
    ds_write_b128 v140, v[44:47] offset:23552
    s_waitcnt lgkmcnt(0)
    s_barrier
    ds_read_b128 v[64:67], v140 offset:0
    ds_read_b128 v[68:71], v140 offset:1024
    ds_read_b128 v[72:75], v140 offset:2048
    ds_read_b128 v[76:79], v140 offset:3072
    ds_read_b128 v[80:83], v140 offset:4096
    ds_read_b128 v[84:87], v140 offset:5120
    s_waitcnt lgkmcnt(4)
    v_add_f32 v16, v16, v64
    v_add_f32 v17, v17, v65
    v_add_f32 v18, v18, v66
    v_add_f32 v19, v19, v67
    v_add_f32 v20, v20, v68
    v_add_f32 v21, v21, v69
    v_add_f32 v22, v22, v70
    v_add_f32 v23, v23, v71
    s_waitcnt lgkmcnt(2)
    v_add_f32 v16, v16, v72
    v_add_f32 v17, v17, v73
    v_add_f32 v18, v18, v74
    v_add_f32 v19, v19, v75
    v_add_f32 v20, v20, v76
    v_add_f32 v21, v21, v77
    v_add_f32 v22, v22, v78
    v_add_f32 v23, v23, v79
    s_waitcnt lgkmcnt(0)
    v_add_f32 v16, v16, v80
    v_add_f32 v17, v17, v81
    v_add_f32 v18, v18, v82
    v_add_f32 v19, v19, v83
    v_add_f32 v20, v20, v84
    v_add_f32 v21, v21, v85
    v_add_f32 v22, v22, v86
    v_add_f32 v23, v23, v87
K2_EPI:
    s_lshl_b32 s19, s3, 10
    s_add_u32 s19, s19, 152576
    v_and_b32 v48, 1023, v141
    v_add_u32 v48, s19, v48
    v_add_u32 v49, s19, v15
    s_lshl_b32 s18, s7, 10
    s_add_u32 s18, s18, s11
    v_cvt_pk_bf16_f32 v44, v16, v17
    v_cvt_pk_bf16_f32 v45, v18, v19
    v_cvt_pk_bf16_f32 v46, v20, v21
    v_cvt_pk_bf16_f32 v47, v22, v23
    v_lshlrev_b32 v16, 16, v44
    v_and_b32 v17, s47, v44
    v_lshlrev_b32 v18, 16, v45
    v_and_b32 v19, s47, v45
    v_lshlrev_b32 v20, 16, v46
    v_and_b32 v21, s47, v46
    v_lshlrev_b32 v22, 16, v47
    v_and_b32 v23, s47, v47
    v_dot2_f32_bf16 v16, v4, s36, v16
    v_dot2_f32_bf16 v17, v5, s36, v17
    v_dot2_f32_bf16 v18, v6, s36, v18
    v_dot2_f32_bf16 v19, v7, s36, v19
    v_dot2_f32_bf16 v20, v8, s36, v20
    v_dot2_f32_bf16 v21, v9, s36, v21
    v_dot2_f32_bf16 v22, v10, s36, v22
    v_dot2_f32_bf16 v23, v11, s36, v23
    v_cvt_pk_bf16_f32 v44, v16, v17
    v_cvt_pk_bf16_f32 v45, v18, v19
    v_cvt_pk_bf16_f32 v46, v20, v21
    v_cvt_pk_bf16_f32 v47, v22, v23
    v_lshlrev_b32 v16, 16, v44
    v_and_b32 v17, s47, v44
    v_lshlrev_b32 v18, 16, v45
    v_and_b32 v19, s47, v45
    v_lshlrev_b32 v20, 16, v46
    v_and_b32 v21, s47, v46
    v_lshlrev_b32 v22, 16, v47
    v_and_b32 v23, s47, v47
    v_dot2_f32_bf16 v16, v4, s37, v16
    v_dot2_f32_bf16 v17, v5, s37, v17
    v_dot2_f32_bf16 v18, v6, s37, v18
    v_dot2_f32_bf16 v19, v7, s37, v19
    v_dot2_f32_bf16 v20, v8, s37, v20
    v_dot2_f32_bf16 v21, v9, s37, v21
    v_dot2_f32_bf16 v22, v10, s37, v22
    v_dot2_f32_bf16 v23, v11, s37, v23
    s_nop 0
    v_cvt_pk_bf16_f32 v44, v16, v17
    v_cvt_pk_bf16_f32 v45, v18, v19
    ds_write_b64 v48, v[44:45] offset:0
    v_cvt_pk_bf16_f32 v46, v20, v21
    v_cvt_pk_bf16_f32 v47, v22, v23
    ds_write_b64 v48, v[46:47] offset:32
    ds_read_b128 v[44:47], v49
    s_waitcnt lgkmcnt(0)
    buffer_store_dwordx4 v[44:47], v15, s[68:71], s18 offen sc1
    s_barrier
    buffer_load_dwordx4 v[224:227], v15, s[68:71], s42 offen offset:2048
    buffer_load_dwordx4 v[228:231], v15, s[68:71], s43 offen offset:0
    buffer_load_dwordx4 v[232:235], v15, s[68:71], s43 offen offset:1024
    buffer_load_dwordx4 v[236:239], v15, s[68:71], s43 offen offset:2048
    buffer_load_dwordx4 v[240:243], v15, s[68:71], s43 offen offset:3072
    s_add_u32 s43, s43, 4096
    buffer_load_dwordx4 v[244:247], v15, s[68:71], s43 offen offset:0
    buffer_load_dwordx4 v[248:251], v15, s[68:71], s43 offen offset:1024
    buffer_load_dwordx4 v[252:255], v15, s[68:71], s43 offen offset:2048
    s_mov_b32 s52, s16
    s_getreg_b32 s72, hwreg(HW_REG_XCC_ID, 0, 4)
    s_mov_b32 s49, s19
    s_mov_b32 s12, s68
    s_mov_b32 s13, s69
    s_mov_b32 s14, s70
    s_mov_b32 s15, s71
    s_add_u32 s8, s4, 0xc00000
    s_addc_u32 s9, s5, 0
    s_and_b32 s9, s9, 0xffff
    s_mov_b32 s10, 0x1c0000
    s_mov_b32 s11, 0x00020000
    s_add_u32 s16, s4, 0x1000000
    s_addc_u32 s17, s5, 0
    s_and_b32 s17, s17, 0xffff
    s_mov_b32 s18, 0x700000
    s_mov_b32 s19, 0x00020000
    s_and_b32 s24, s2, 31
    s_lshr_b32 s25, s2, 5
    s_lshl_b32 s26, s25, 3
    s_add_u32 s26, s26, s3
    s_mov_b32 s47, 0xffff0000
    v_lshrrev_b32 v3, 3, v2
    v_and_b32 v4, 7, v2
    v_lshlrev_b32 v1, 12, v3
    v_lshl_add_u32 v1, v4, 4, v1
    s_lshl_b32 s27, s3, 15
    s_lshl_b32 s28, s24, 7
    s_add_u32 s27, s27, s28
    s_lshl_b32 s29, s25, 18
    s_add_u32 s29, s29, s27
    v_lshlrev_b32 v6, 4, v2
    s_lshl_b32 s30, s26, 6
    s_add_u32 s68, s4, 0x1c00000
    s_addc_u32 s69, s5, 0
    s_and_b32 s69, s69, 0xffff
    s_mov_b32 s70, 0x10000
    s_mov_b32 s71, 0x00020000
    s_add_u32 s72, s72, 1
    s_lshl_b32 s74, s24, 7
    s_add_u32 s74, s74, 0x8000
    s_cmp_lg_u32 s3, 0
    s_cbranch_scc1 K3_NOPUB
    s_lshl_b32 s73, s25, 2
    s_add_u32 s73, s73, s74
    v_mov_b32 v67, s72
    s_mov_b64 exec, 1
    buffer_store_dword v67, off, s[68:71], s73 sc1
    s_mov_b64 exec, -1
K3_NOPUB:
    s_add_u32 s56, s4, 0x1988000
    s_addc_u32 s57, s5, 0
    s_and_b32 s57, s57, 0xffff
    s_mov_b32 s58, 0x188000
    s_mov_b32 s59, 0x00020000
    v_min_u32 v5, 6, v4
    v_lshlrev_b32 v5, 2, v5
    v_lshrrev_b32 v67, 4, v2
    v_lshlrev_b32 v67, 4, v67
    s_lshr_b32 s79, s3, 2
    s_lshl_b32 s79, s79, 6
    s_lshl_b32 s73, s25, 7
    s_add_u32 s79, s79, s73
    s_mul_hi_u32 s76, s26, 0x24924925
    s_lshl_b32 s73, s24, 3
    s_add_u32 s76, s76, s73
    s_lshl_b32 s76, s76, 7
    s_add_u32 s77, s73, s3
    s_lshl_b32 s77, s77, 7
    v_mul_u32_u24 v57, 192, v3
    v_lshl_add_u32 v57, v4, 4, v57
    s_mul_i32 s38, s3, 1536
    s_add_u32 s38, s38, 4096
    v_add_u32 v57, s38, v57
    v_add_u32 v58, 49152, v57
    v_add_u32 v65, 135168, v57
    s_mul_i32 s48, s24, 229376
    s_lshl_b32 s43, s26, 11
    s_add_u32 s48, s48, s43
    v_and_b32 v60, 15, v2
    v_lshrrev_b32 v59, 2, v60
    v_lshrrev_b32 v61, 5, v2
    v_lshl_add_u32 v59, v61, 3, v59
    v_mul_u32_u24 v59, 192, v59
    v_and_b32 v60, 3, v60
    v_lshl_add_u32 v59, v60, 3, v59
    v_bfe_u32 v60, v2, 4, 1
    v_lshl_add_u32 v59, v60, 5, v59
    s_mul_i32 s33, s3, 3072
    s_add_u32 s33, s33, 4096
    s_add_u32 s34, s33, 12352
    s_add_u32 s35, s33, 73728
    s_add_u32 s36, s33, -12224
    s_cmp_lt_u32 s3, 4
    s_cselect_b32 s35, s35, s36
    s_cselect_b32 s45, 1.0, 0
    s_cselect_b32 s46, 0, 1.0
    v_add_u32 v62, s33, v59
    v_add_u32 v63, s35, v59
    v_add_u32 v64, s34, v59
    s_bfe_u32 s37, s2, 0x20003
    s_mov_b32 s37, 0
    s_add_u32 s36, s37, 0
    s_and_b32 s36, s36, 3
    s_mul_i32 s36, s36, 21504
    s_add_u32 s36, s36, 4096
    v_add_u32 v61, s36, v59
    s_add_u32 s36, s37, 1
    s_and_b32 s36, s36, 3
    s_mul_i32 s36, s36, 21504
    s_add_u32 s36, s36, 4096
    v_add_u32 v141, s36, v59
    s_add_u32 s36, s37, 2
    s_and_b32 s36, s36, 3
    s_mul_i32 s36, s36, 21504
    s_add_u32 s36, s36, 4096
    v_add_u32 v142, s36, v59
    s_add_u32 s36, s37, 3
    s_and_b32 s36, s36, 3
    s_mul_i32 s36, s36, 21504
    s_add_u32 s36, s36, 4096
    v_add_u32 v59, s36, v59
    v_and_b32 v56, 31, v2
    v_lshlrev_b32 v7, 1, v56
    v_lshlrev_b32 v56, 3, v56
    s_lshl_b32 s37, s3, 8
    v_add_u32 v55, s37, v56
    s_mov_b32 s40, 0x3f803f80
    s_mov_b32 s75, 200000
    s_mov_b32 s20, s88
    s_mov_b32 s21, s89
    s_and_b32 s21, s21, 0xffff
    s_mov_b32 s22, 0xe00
    s_mov_b32 s23, 0x00020000
    s_mov_b32 s60, s80
    s_mov_b32 s61, s81
    s_and_b32 s61, s61, 0xffff
    s_mov_b32 s62, 0x380
    s_mov_b32 s63, 0x00020000
    s_mov_b32 s64, s82
    s_mov_b32 s65, s83
    s_and_b32 s65, s65, 0xffff
    s_mov_b32 s66, 0x1c0000
    s_mov_b32 s67, 0x00020000
    v_mov_b32 v128, 0
    v_mov_b32 v129, 0
    v_mov_b32 v130, 0
    v_mov_b32 v131, 0
    s_lshl_b32 s53, s2, 8
    s_add_u32 s53, s53, 0x1d40080
    s_waitcnt vmcnt(20)
    v_dot2_f32_bf16 v128, v144, s40, v128
    v_dot2_f32_bf16 v129, v145, s40, v129
    v_dot2_f32_bf16 v130, v146, s40, v130
    v_dot2_f32_bf16 v131, v147, s40, v131
    v_dot2_f32_bf16 v128, v148, s40, v128
    v_dot2_f32_bf16 v129, v149, s40, v129
    v_dot2_f32_bf16 v130, v150, s40, v130
    v_dot2_f32_bf16 v131, v151, s40, v131
    v_dot2_f32_bf16 v128, v152, s40, v128
    v_dot2_f32_bf16 v129, v153, s40, v129
    v_dot2_f32_bf16 v130, v154, s40, v130
    v_dot2_f32_bf16 v131, v155, s40, v131
    v_dot2_f32_bf16 v128, v156, s40, v128
    v_dot2_f32_bf16 v129, v157, s40, v129
    v_dot2_f32_bf16 v130, v158, s40, v130
    v_dot2_f32_bf16 v131, v159, s40, v131
    v_dot2_f32_bf16 v128, v160, s40, v128
    v_dot2_f32_bf16 v129, v161, s40, v129
    v_dot2_f32_bf16 v130, v162, s40, v130
    v_dot2_f32_bf16 v131, v163, s40, v131
    v_dot2_f32_bf16 v128, v164, s40, v128
    v_dot2_f32_bf16 v129, v165, s40, v129
    v_dot2_f32_bf16 v130, v166, s40, v130
    v_dot2_f32_bf16 v131, v167, s40, v131
    v_dot2_f32_bf16 v128, v168, s40, v128
    v_dot2_f32_bf16 v129, v169, s40, v129
    v_dot2_f32_bf16 v130, v170, s40, v130
    v_dot2_f32_bf16 v131, v171, s40, v131
    v_dot2_f32_bf16 v128, v172, s40, v128
    v_dot2_f32_bf16 v129, v173, s40, v129
    v_dot2_f32_bf16 v130, v174, s40, v130
    v_dot2_f32_bf16 v131, v175, s40, v131
    s_waitcnt vmcnt(0)
    s_mov_b32 s28, s27
    buffer_load_dwordx4 v[8:11], v1, s[8:11], s28 offen
    s_add_u32 s28, s28, 0x40000
    buffer_load_dwordx4 v[12:15], v1, s[8:11], s28 offen
    s_add_u32 s28, s28, 0x40000
    buffer_load_dwordx4 v[16:19], v1, s[8:11], s28 offen
    s_add_u32 s28, s28, 0x40000
    buffer_load_dwordx4 v[20:23], v1, s[8:11], s28 offen
    s_add_u32 s28, s28, 0x40000
    buffer_load_dwordx4 v[24:27], v1, s[8:11], s28 offen
    s_add_u32 s28, s28, 0x40000
    buffer_load_dwordx4 v[28:31], v1, s[8:11], s28 offen
    s_add_u32 s28, s28, 0x40000
    buffer_load_dwordx4 v[32:35], v1, s[8:11], s28 offen
    buffer_load_dwordx4 v[68:71], v1, s[8:11], s29 offen
    buffer_load_ushort v140, v7, s[20:23], s30 offen
    s_waitcnt vmcnt(9)
    v_dot2_f32_bf16 v128, v176, s40, v128
    v_dot2_f32_bf16 v129, v177, s40, v129
    v_dot2_f32_bf16 v130, v178, s40, v130
    v_dot2_f32_bf16 v131, v179, s40, v131
    v_dot2_f32_bf16 v128, v180, s40, v128
    v_dot2_f32_bf16 v129, v181, s40, v129
    v_dot2_f32_bf16 v130, v182, s40, v130
    v_dot2_f32_bf16 v131, v183, s40, v131
    v_dot2_f32_bf16 v128, v184, s40, v128
    v_dot2_f32_bf16 v129, v185, s40, v129
    v_dot2_f32_bf16 v130, v186, s40, v130
    v_dot2_f32_bf16 v131, v187, s40, v131
    v_dot2_f32_bf16 v128, v188, s40, v128
    v_dot2_f32_bf16 v129, v189, s40, v129
    v_dot2_f32_bf16 v130, v190, s40, v130
    v_dot2_f32_bf16 v131, v191, s40, v131
    v_dot2_f32_bf16 v128, v192, s40, v128
    v_dot2_f32_bf16 v129, v193, s40, v129
    v_dot2_f32_bf16 v130, v194, s40, v130
    v_dot2_f32_bf16 v131, v195, s40, v131
    v_dot2_f32_bf16 v128, v196, s40, v128
    v_dot2_f32_bf16 v129, v197, s40, v129
    v_dot2_f32_bf16 v130, v198, s40, v130
    v_dot2_f32_bf16 v131, v199, s40, v131
    v_dot2_f32_bf16 v128, v200, s40, v128
    v_dot2_f32_bf16 v129, v201, s40, v129
    v_dot2_f32_bf16 v130, v202, s40, v130
    v_dot2_f32_bf16 v131, v203, s40, v131
    v_dot2_f32_bf16 v128, v204, s40, v128
    v_dot2_f32_bf16 v129, v205, s40, v129
    v_dot2_f32_bf16 v130, v206, s40, v130
    v_dot2_f32_bf16 v131, v207, s40, v131
    v_dot2_f32_bf16 v128, v208, s40, v128
    v_dot2_f32_bf16 v129, v209, s40, v129
    v_dot2_f32_bf16 v130, v210, s40, v130
    v_dot2_f32_bf16 v131, v211, s40, v131
    v_dot2_f32_bf16 v128, v212, s40, v128
    v_dot2_f32_bf16 v129, v213, s40, v129
    v_dot2_f32_bf16 v130, v214, s40, v130
    v_dot2_f32_bf16 v131, v215, s40, v131
    v_dot2_f32_bf16 v128, v216, s40, v128
    v_dot2_f32_bf16 v129, v217, s40, v129
    v_dot2_f32_bf16 v130, v218, s40, v130
    v_dot2_f32_bf16 v131, v219, s40, v131
    v_dot2_f32_bf16 v128, v220, s40, v128
    v_dot2_f32_bf16 v129, v221, s40, v129
    v_dot2_f32_bf16 v130, v222, s40, v130
    v_dot2_f32_bf16 v131, v223, s40, v131
    v_dot2_f32_bf16 v128, v224, s40, v128
    v_dot2_f32_bf16 v129, v225, s40, v129
    v_dot2_f32_bf16 v130, v226, s40, v130
    v_dot2_f32_bf16 v131, v227, s40, v131
    v_dot2_f32_bf16 v128, v228, s40, v128
    v_dot2_f32_bf16 v129, v229, s40, v129
    v_dot2_f32_bf16 v130, v230, s40, v130
    v_dot2_f32_bf16 v131, v231, s40, v131
    v_dot2_f32_bf16 v128, v232, s40, v128
    v_dot2_f32_bf16 v129, v233, s40, v129
    v_dot2_f32_bf16 v130, v234, s40, v130
    v_dot2_f32_bf16 v131, v235, s40, v131
    v_dot2_f32_bf16 v128, v236, s40, v128
    v_dot2_f32_bf16 v129, v237, s40, v129
    v_dot2_f32_bf16 v130, v238, s40, v130
    v_dot2_f32_bf16 v131, v239, s40, v131
    v_dot2_f32_bf16 v128, v240, s40, v128
    v_dot2_f32_bf16 v129, v241, s40, v129
    v_dot2_f32_bf16 v130, v242, s40, v130
    v_dot2_f32_bf16 v131, v243, s40, v131
    v_dot2_f32_bf16 v128, v244, s40, v128
    v_dot2_f32_bf16 v129, v245, s40, v129
    v_dot2_f32_bf16 v130, v246, s40, v130
    v_dot2_f32_bf16 v131, v247, s40, v131
    v_dot2_f32_bf16 v128, v248, s40, v128
    v_dot2_f32_bf16 v129, v249, s40, v129
    v_dot2_f32_bf16 v130, v250, s40, v130
    v_dot2_f32_bf16 v131, v251, s40, v131
    v_dot2_f32_bf16 v128, v252, s40, v128
    v_dot2_f32_bf16 v129, v253, s40, v129
    v_dot2_f32_bf16 v130, v254, s40, v130
    v_dot2_f32_bf16 v131, v255, s40, v131
    v_mov_b32 v138, 0
    v_mov_b32 v139, 0
    v_cmp_gt_u32 s[50:51], 32, v2
    s_nop 1
    v_add_f32 v128, v128, v129
    v_add_f32 v130, v130, v131
    v_add_f32 v128, v128, v130
    v_mov_b32 v129, v128
    s_nop 0
    v_permlane32_swap_b32 v128, v129
    v_add_f32 v128, v128, v129
    v_cvt_pk_bf16_f32 v129, v128, v128
    v_lshlrev_b32 v129, 16, v129
    v_sub_f32 v129, v128, v129
    v_cvt_pk_bf16_f32 v128, v128, v129
    v_cndmask_b32 v136, 0, v128, s[50:51]
    s_waitcnt vmcnt(1)
K3_HP:
    v_max3_u32 v40, v8, v9, v10
    v_max3_u32 v41, v11, v12, v13
    v_max3_u32 v40, v40, v14, v15
    v_max3_u32 v41, v41, v16, v17
    v_max3_u32 v40, v40, v18, v19
    v_max3_u32 v41, v41, v20, v21
    v_max3_u32 v40, v40, v22, v23
    v_max3_u32 v41, v41, v24, v25
    v_max3_u32 v40, v40, v26, v27
    v_max3_u32 v41, v41, v28, v29
    v_max3_u32 v40, v40, v30, v31
    v_max3_u32 v41, v41, v32, v33
    v_max3_u32 v40, v40, v34, v35
    v_max3_u32 v41, v41, v68, v69
    v_max3_u32 v40, v40, v70, v71
    v_max_u32 v40, v40, v41
    v_cmp_eq_u32 vcc, -1, v40
    s_cmp_eq_u64 vcc, 0
    s_cbranch_scc1 K3_HG
    s_mov_b64 exec, vcc
K3_HP2:
    s_mov_b32 s28, s27
    buffer_load_dwordx4 v[8:11], v1, s[8:11], s28 offen sc1
    s_add_u32 s28, s28, 0x40000
    buffer_load_dwordx4 v[12:15], v1, s[8:11], s28 offen sc1
    s_add_u32 s28, s28, 0x40000
    buffer_load_dwordx4 v[16:19], v1, s[8:11], s28 offen sc1
    s_add_u32 s28, s28, 0x40000
    buffer_load_dwordx4 v[20:23], v1, s[8:11], s28 offen sc1
    s_add_u32 s28, s28, 0x40000
    buffer_load_dwordx4 v[24:27], v1, s[8:11], s28 offen sc1
    s_add_u32 s28, s28, 0x40000
    buffer_load_dwordx4 v[28:31], v1, s[8:11], s28 offen sc1
    s_add_u32 s28, s28, 0x40000
    buffer_load_dwordx4 v[32:35], v1, s[8:11], s28 offen sc1
    buffer_load_dwordx4 v[68:71], v1, s[8:11], s29 offen sc1
    s_waitcnt vmcnt(0)
    s_sub_u32 s75, s75, 1
    s_cbranch_scc0 K3_HP
K3_HG:
    s_mov_b64 exec, -1
    ds_write_b128 v57, v[8:11] offset:0
    ds_write_b128 v57, v[12:15] offset:12288
    ds_write_b128 v57, v[16:19] offset:24576
    ds_write_b128 v57, v[20:23] offset:36864
    ds_write_b128 v58, v[24:27] offset:0
    ds_write_b128 v58, v[28:31] offset:12288
    ds_write_b128 v58, v[32:35] offset:24576
    ds_write_b128 v65, v[68:71]
    v_mov_b32 v40, 0
    v_mov_b32 v41, 0
    v_mov_b32 v42, 0
    v_mov_b32 v43, 0
    v_mov_b32 v44, 0
    v_mov_b32 v45, 0
    s_mul_i32 s31, s3, 14336
    s_mul_i32 s33, s25, 229376
    s_add_u32 s33, s33, s31
    s_add_u32 s34, s33, 114688
    s_mul_i32 s32, s24, 229376
    s_add_u32 s31, s31, s32
    s_add_u32 s32, s31, 114688
    s_waitcnt lgkmcnt(0)
    s_barrier
    ds_read_b64_tr_b16 v[104:105], v61 offset:0
    ds_read_b64_tr_b16 v[106:107], v61 offset:768
    ds_read_b64_tr_b16 v[8:9], v62 offset:0
    ds_read_b64_tr_b16 v[10:11], v62 offset:768
    ds_read_b64_tr_b16 v[108:109], v61 offset:3072
    ds_read_b64_tr_b16 v[110:111], v61 offset:3840
    ds_read_b64_tr_b16 v[12:13], v62 offset:24576
    ds_read_b64_tr_b16 v[14:15], v62 offset:25344
    ds_read_b64_tr_b16 v[112:113], v61 offset:6144
    ds_read_b64_tr_b16 v[114:115], v61 offset:6912
    ds_read_b64_tr_b16 v[16:17], v62 offset:49152
    ds_read_b64_tr_b16 v[18:19], v62 offset:49920
    ds_read_b64_tr_b16 v[20:21], v63 offset:0
    ds_read_b64_tr_b16 v[22:23], v63 offset:768
    ds_read_b64_tr_b16 v[24:25], v64 offset:0
    ds_read_b64_tr_b16 v[26:27], v64 offset:768
    ds_read_b64_tr_b16 v[28:29], v64 offset:24576
    ds_read_b64_tr_b16 v[30:31], v64 offset:25344
    ds_read_b64_tr_b16 v[32:33], v64 offset:49152
    ds_read_b64_tr_b16 v[34:35], v64 offset:49920
    buffer_load_dwordx4 v[68:71], v67, s[60:63], s79 offen
    s_cmp_lg_u32 s3, 7
    s_cbranch_scc1 K3_NOCL
    v_mov_b32 v120, 0
    v_mov_b32 v121, 0
    v_mov_b32 v122, 0
    v_mov_b32 v123, 0
    v_lshrrev_b32 v124, 2, v2
    v_and_b32 v125, 3, v2
    v_lshlrev_b32 v125, 2, v125
    v_lshl_add_u32 v126, v124, 14, v125
    v_add_u32 v127, v126, v125
    s_waitcnt vmcnt(1)
    s_sub_u32 s53, s53, 128
    buffer_store_dword v120, v132, s[12:15], s53 offen
    s_mov_b32 exec_lo, -1
    s_mov_b32 exec_hi, 0
    s_lshl_b32 s29, s2, 5
    s_add_u32 s29, s29, 0x1d00000
    buffer_store_dwordx2 v[120:121], v127, s[12:15], s29 offen
    s_lshl_b32 s28, s2, 4
    s_add_u32 s28, s28, 0x1d20000
    buffer_store_dword v120, v126, s[12:15], s28 offen
    s_cmp_ge_u32 s2, 32
    s_cbranch_scc1 K3_NOCL2
    s_add_u32 s29, s29, 7168
    buffer_store_dwordx2 v[120:121], v127, s[12:15], s29 offen
K3_NOCL2:
    s_mov_b64 exec, -1
K3_NOCL:
    ds_read_b64_tr_b16 v[116:117], v61 offset:9216
    ds_read_b64_tr_b16 v[118:119], v61 offset:9984
    s_waitcnt lgkmcnt(15)
    v_mfma_f32_32x32x16_bf16 v[72:87], v[144:147], v[104:107], 0
    v_dot2_f32_bf16 v40, v8, s40, v40
    v_dot2_f32_bf16 v41, v8, v8, v41
    v_dot2_f32_bf16 v40, v9, s40, v40
    v_dot2_f32_bf16 v41, v9, v9, v41
    v_dot2_f32_bf16 v40, v10, s40, v40
    v_dot2_f32_bf16 v41, v10, v10, v41
    v_dot2_f32_bf16 v40, v11, s40, v40
    v_dot2_f32_bf16 v41, v11, v11, v41
    s_waitcnt lgkmcnt(14)
    v_dot2_f32_bf16 v40, v12, s40, v40
    v_dot2_f32_bf16 v41, v12, v12, v41
    ds_read_b64_tr_b16 v[104:105], v61 offset:12288
    ds_read_b64_tr_b16 v[106:107], v61 offset:13056
    v_mfma_f32_32x32x16_bf16 v[72:87], v[148:151], v[108:111], v[72:87]
    v_dot2_f32_bf16 v40, v13, s40, v40
    v_dot2_f32_bf16 v41, v13, v13, v41
    v_dot2_f32_bf16 v40, v14, s40, v40
    v_dot2_f32_bf16 v41, v14, v14, v41
    v_dot2_f32_bf16 v40, v15, s40, v40
    v_dot2_f32_bf16 v41, v15, v15, v41
    s_waitcnt lgkmcnt(12)
    v_dot2_f32_bf16 v40, v16, s40, v40
    v_dot2_f32_bf16 v41, v16, v16, v41
    v_dot2_f32_bf16 v40, v17, s40, v40
    v_dot2_f32_bf16 v41, v17, v17, v41
    ds_read_b64_tr_b16 v[108:109], v61 offset:15360
    ds_read_b64_tr_b16 v[110:111], v61 offset:16128
    v_mfma_f32_32x32x16_bf16 v[72:87], v[152:155], v[112:115], v[72:87]
    v_dot2_f32_bf16 v40, v18, s40, v40
    v_dot2_f32_bf16 v41, v18, v18, v41
    v_dot2_f32_bf16 v40, v19, s40, v40
    v_dot2_f32_bf16 v41, v19, v19, v41
    s_waitcnt lgkmcnt(12)
    v_dot2_f32_bf16 v44, v20, s40, v44
    v_dot2_f32_bf16 v45, v20, v20, v45
    v_dot2_f32_bf16 v44, v21, s40, v44
    v_dot2_f32_bf16 v45, v21, v21, v45
    v_dot2_f32_bf16 v44, v22, s40, v44
    v_dot2_f32_bf16 v45, v22, v22, v45
    ds_read_b64_tr_b16 v[112:113], v61 offset:18432
    ds_read_b64_tr_b16 v[114:115], v61 offset:19200
    s_waitcnt lgkmcnt(6)
    v_mfma_f32_32x32x16_bf16 v[72:87], v[156:159], v[116:119], v[72:87]
    v_dot2_f32_bf16 v44, v23, s40, v44
    v_dot2_f32_bf16 v45, v23, v23, v45
    v_dot2_f32_bf16 v42, v24, s40, v42
    v_dot2_f32_bf16 v43, v24, v24, v43
    v_dot2_f32_bf16 v42, v25, s40, v42
    v_dot2_f32_bf16 v43, v25, v25, v43
    v_dot2_f32_bf16 v42, v26, s40, v42
    v_dot2_f32_bf16 v43, v26, v26, v43
    v_dot2_f32_bf16 v42, v27, s40, v42
    v_dot2_f32_bf16 v43, v27, v27, v43
    ds_read_b64_tr_b16 v[116:117], v141 offset:0
    ds_read_b64_tr_b16 v[118:119], v141 offset:768
    s_waitcnt lgkmcnt(6)
    v_mfma_f32_32x32x16_bf16 v[72:87], v[160:163], v[104:107], v[72:87]
    v_dot2_f32_bf16 v42, v28, s40, v42
    v_dot2_f32_bf16 v43, v28, v28, v43
    v_dot2_f32_bf16 v42, v29, s40, v42
    v_dot2_f32_bf16 v43, v29, v29, v43
    v_dot2_f32_bf16 v42, v30, s40, v42
    v_dot2_f32_bf16 v43, v30, v30, v43
    v_dot2_f32_bf16 v42, v31, s40, v42
    v_dot2_f32_bf16 v43, v31, v31, v43
    v_dot2_f32_bf16 v42, v32, s40, v42
    v_dot2_f32_bf16 v43, v32, v32, v43
    ds_read_b64_tr_b16 v[104:105], v141 offset:3072
    ds_read_b64_tr_b16 v[106:107], v141 offset:3840
    s_waitcnt lgkmcnt(6)
    v_mfma_f32_32x32x16_bf16 v[72:87], v[164:167], v[108:111], v[72:87]
    v_dot2_f32_bf16 v42, v33, s40, v42
    v_dot2_f32_bf16 v43, v33, v33, v43
    v_dot2_f32_bf16 v42, v34, s40, v42
    v_dot2_f32_bf16 v43, v34, v34, v43
    v_dot2_f32_bf16 v42, v35, s40, v42
    v_dot2_f32_bf16 v43, v35, v35, v43
    s_nop 3
    v_fmac_f32 v40, s45, v44
    v_fmac_f32 v41, s45, v45
    v_fmac_f32 v42, s46, v44
    ds_read_b64_tr_b16 v[108:109], v61 offset:64
    ds_read_b64_tr_b16 v[110:111], v61 offset:832
    s_waitcnt lgkmcnt(6)
    v_mfma_f32_32x32x16_bf16 v[72:87], v[168:171], v[112:115], v[72:87]
    v_fmac_f32 v43, s46, v45
    v_mov_b32 v44, v40
    v_mov_b32 v45, v41
    v_mov_b32 v46, v42
    v_mov_b32 v47, v43
    s_nop 0
    v_permlane32_swap_b32 v40, v44
    v_permlane32_swap_b32 v41, v45
    v_permlane32_swap_b32 v42, v46
    v_permlane32_swap_b32 v43, v47
    ds_read_b64_tr_b16 v[112:113], v141 offset:6144
    ds_read_b64_tr_b16 v[114:115], v141 offset:6912
    s_waitcnt lgkmcnt(6)
    v_mfma_f32_32x32x16_bf16 v[72:87], v[172:175], v[116:119], v[72:87]
    v_add_f32 v40, v40, v44
    v_add_f32 v41, v41, v45
    v_add_f32 v42, v42, v46
    v_add_f32 v43, v43, v47
    ds_write_b64 v55, v[40:41]
    ds_write_b64 v55, v[42:43] offset:2048
    ds_read_b64_tr_b16 v[116:117], v61 offset:3136
    ds_read_b64_tr_b16 v[118:119], v61 offset:3904
    s_waitcnt lgkmcnt(8)
    v_mfma_f32_32x32x16_bf16 v[72:87], v[176:179], v[104:107], v[72:87]
    ds_read_b64_tr_b16 v[104:105], v141 offset:9216
    ds_read_b64_tr_b16 v[106:107], v141 offset:9984
    s_waitcnt lgkmcnt(8)
    v_mfma_f32_32x32x16_bf16 v[88:103], v[144:147], v[108:111], 0
    buffer_load_dwordx4 v[144:147], v6, s[56:59], s33 offen offset:0
    s_waitcnt lgkmcnt(4)
    s_barrier
    ds_read_b64_tr_b16 v[108:109], v61 offset:6208
    ds_read_b64_tr_b16 v[110:111], v61 offset:6976
    v_mfma_f32_32x32x16_bf16 v[72:87], v[180:183], v[112:115], v[72:87]
    ds_read_b64 v[8:9], v56 offset:0
    ds_read_b64 v[10:11], v56 offset:256
    ds_read_b64 v[12:13], v56 offset:512
    ds_read_b64 v[14:15], v56 offset:768
    ds_read_b64 v[16:17], v56 offset:1024
    ds_read_b64_tr_b16 v[112:113], v141 offset:12288
    ds_read_b64_tr_b16 v[114:115], v141 offset:13056
    s_waitcnt lgkmcnt(11)
    v_mfma_f32_32x32x16_bf16 v[88:103], v[148:151], v[116:119], v[88:103]
    buffer_load_dwordx4 v[148:151], v6, s[56:59], s34 offen offset:0
    ds_read_b64 v[18:19], v56 offset:1280
    ds_read_b64 v[20:21], v56 offset:1536
    ds_read_b64 v[22:23], v56 offset:1792
    ds_read_b64 v[24:25], v56 offset:2048
    ds_read_b64 v[26:27], v56 offset:2304
    ds_read_b64_tr_b16 v[116:117], v61 offset:9280
    ds_read_b64_tr_b16 v[118:119], v61 offset:10048
    s_waitcnt lgkmcnt(15)
    v_mfma_f32_32x32x16_bf16 v[72:87], v[184:187], v[104:107], v[72:87]
    ds_read_b64 v[28:29], v56 offset:2560
    ds_read_b64 v[30:31], v56 offset:2816
    ds_read_b64 v[32:33], v56 offset:3072
    ds_read_b64 v[34:35], v56 offset:3328
    ds_read_b64 v[36:37], v56 offset:3584
    ds_read_b64_tr_b16 v[104:105], v141 offset:15360
    ds_read_b64_tr_b16 v[106:107], v141 offset:16128
    s_waitcnt lgkmcnt(15)
    v_mfma_f32_32x32x16_bf16 v[88:103], v[152:155], v[108:111], v[88:103]
    buffer_load_dwordx4 v[152:155], v6, s[56:59], s33 offen offset:1024
    ds_read_b64 v[38:39], v56 offset:3840
    s_mov_b32 s36, 0x3b124925
    s_mov_b32 s37, 0x3727c5ac
    v_mov_b32 v46, 0
    v_mov_b32 v47, 0
    ds_read_b64_tr_b16 v[108:109], v61 offset:12352
    ds_read_b64_tr_b16 v[110:111], v61 offset:13120
    s_waitcnt lgkmcnt(15)
    v_mfma_f32_32x32x16_bf16 v[72:87], v[188:191], v[112:115], v[72:87]
    v_mov_b32 v50, 0
    v_mov_b32 v51, 0
    s_waitcnt lgkmcnt(14)
    v_add_f32 v8, v8, v10
    v_add_f32 v9, v9, v11
    v_add_f32 v12, v12, v14
    ds_read_b64_tr_b16 v[112:113], v141 offset:18432
    ds_read_b64_tr_b16 v[114:115], v141 offset:19200
    s_waitcnt lgkmcnt(12)
    v_mfma_f32_32x32x16_bf16 v[88:103], v[156:159], v[116:119], v[88:103]
    buffer_load_dwordx4 v[156:159], v6, s[56:59], s34 offen offset:1024
    v_add_f32 v13, v13, v15
    v_add_f32 v16, v16, v18
    v_add_f32 v17, v17, v19
    v_add_f32 v20, v20, v22
    v_add_f32 v21, v21, v23
    ds_read_b64_tr_b16 v[116:117], v61 offset:15424
    ds_read_b64_tr_b16 v[118:119], v61 offset:16192
    s_waitcnt lgkmcnt(7)
    v_mfma_f32_32x32x16_bf16 v[72:87], v[192:195], v[104:107], v[72:87]
    v_add_f32 v8, v8, v12
    v_add_f32 v9, v9, v13
    v_add_f32 v16, v16, v20
    v_add_f32 v17, v17, v21
    v_add_f32 v8, v8, v16
    ds_read_b64_tr_b16 v[104:105], v142 offset:0
    ds_read_b64_tr_b16 v[106:107], v142 offset:768
    s_waitcnt lgkmcnt(6)
    v_mfma_f32_32x32x16_bf16 v[88:103], v[160:163], v[108:111], v[88:103]
    buffer_load_dwordx4 v[160:163], v6, s[56:59], s33 offen offset:2048
    v_add_f32 v9, v9, v17
    v_mul_f32 v40, s36, v8
    v_mul_f32 v41, s36, v9
    v_fma_f32 v41, -v40, v40, v41
    v_max_f32 v41, 0, v41
    ds_read_b64_tr_b16 v[108:109], v61 offset:18496
    ds_read_b64_tr_b16 v[110:111], v61 offset:19264
    s_waitcnt lgkmcnt(6)
    v_mfma_f32_32x32x16_bf16 v[72:87], v[196:199], v[112:115], v[72:87]
    v_cvt_pk_bf16_f32 v44, -v40, -v40
    v_cvt_pk_bf16_f32 v41, v41, v41
    v_lshlrev_b32 v41, 16, v41
    v_add_f32 v41, s37, v41
    v_cvt_pk_bf16_f32 v41, v41, v41
    ds_read_b64_tr_b16 v[112:113], v142 offset:3072
    ds_read_b64_tr_b16 v[114:115], v142 offset:3840
    s_waitcnt lgkmcnt(6)
    v_mfma_f32_32x32x16_bf16 v[88:103], v[164:167], v[116:119], v[88:103]
    buffer_load_dwordx4 v[164:167], v6, s[56:59], s34 offen offset:2048
    v_lshlrev_b32 v41, 16, v41
    v_sqrt_f32 v41, v41
    s_nop 0
    v_cvt_pk_bf16_f32 v45, v41, 0
    v_lshlrev_b32 v54, 16, v45
    ds_read_b64_tr_b16 v[116:117], v141 offset:64
    ds_read_b64_tr_b16 v[118:119], v141 offset:832
    s_waitcnt lgkmcnt(6)
    v_mfma_f32_32x32x16_bf16 v[72:87], v[200:203], v[104:107], v[72:87]
    v_rcp_f32 v41, v54
    s_nop 0
    v_mul_f32 v52, 0xc0135761, v41
    v_mul_f32 v41, v41, v41
    v_mul_f32 v41, 0x3d372713, v41
    ds_read_b64_tr_b16 v[104:105], v142 offset:6144
    ds_read_b64_tr_b16 v[106:107], v142 offset:6912
    s_waitcnt lgkmcnt(6)
    v_mfma_f32_32x32x16_bf16 v[88:103], v[168:171], v[108:111], v[88:103]
    buffer_load_dwordx4 v[168:171], v6, s[56:59], s33 offen offset:3072
    s_add_u32 s33, s33, 4096
    v_mul_f32 v53, v41, v52
    v_add_f32 v24, v24, v26
    v_add_f32 v25, v25, v27
    v_add_f32 v28, v28, v30
    v_add_f32 v29, v29, v31
    ds_read_b64_tr_b16 v[108:109], v141 offset:3136
    ds_read_b64_tr_b16 v[110:111], v141 offset:3904
    s_waitcnt lgkmcnt(6)
    v_mfma_f32_32x32x16_bf16 v[72:87], v[204:207], v[112:115], v[72:87]
    v_add_f32 v32, v32, v34
    v_add_f32 v33, v33, v35
    v_add_f32 v36, v36, v38
    v_add_f32 v37, v37, v39
    v_add_f32 v24, v24, v28
    ds_read_b64_tr_b16 v[112:113], v142 offset:9216
    ds_read_b64_tr_b16 v[114:115], v142 offset:9984
    s_waitcnt lgkmcnt(6)
    v_mfma_f32_32x32x16_bf16 v[88:103], v[172:175], v[116:119], v[88:103]
    buffer_load_dwordx4 v[172:175], v6, s[56:59], s34 offen offset:3072
    s_add_u32 s34, s34, 4096
    v_add_f32 v25, v25, v29
    v_add_f32 v32, v32, v36
    v_add_f32 v33, v33, v37
    v_add_f32 v24, v24, v32
    v_add_f32 v25, v25, v33
    ds_read_b64_tr_b16 v[116:117], v141 offset:6208
    ds_read_b64_tr_b16 v[118:119], v141 offset:6976
    s_waitcnt lgkmcnt(6)
    v_mfma_f32_32x32x16_bf16 v[72:87], v[208:211], v[104:107], v[72:87]
    v_mul_f32 v40, s36, v24
    v_mul_f32 v41, s36, v25
    v_fma_f32 v41, -v40, v40, v41
    v_max_f32 v41, 0, v41
    v_cvt_pk_bf16_f32 v48, -v40, -v40
    ds_read_b64_tr_b16 v[104:105], v142 offset:12288
    ds_read_b64_tr_b16 v[106:107], v142 offset:13056
    s_waitcnt lgkmcnt(6)
    v_mfma_f32_32x32x16_bf16 v[88:103], v[176:179], v[108:111], v[88:103]
    buffer_load_dwordx4 v[176:179], v6, s[56:59], s33 offen offset:0
    v_cvt_pk_bf16_f32 v41, v41, v41
    v_lshlrev_b32 v41, 16, v41
    v_add_f32 v41, s37, v41
    v_cvt_pk_bf16_f32 v41, v41, v41
    v_lshlrev_b32 v41, 16, v41
    ds_read_b64_tr_b16 v[108:109], v141 offset:9280
    ds_read_b64_tr_b16 v[110:111], v141 offset:10048
    s_waitcnt lgkmcnt(6)
    v_mfma_f32_32x32x16_bf16 v[72:87], v[212:215], v[112:115], v[72:87]
    v_sqrt_f32 v41, v41
    s_nop 0
    v_cvt_pk_bf16_f32 v49, v41, 0
    v_lshlrev_b32 v66, 16, v49
    v_rcp_f32 v41, v66
    ds_read_b64_tr_b16 v[112:113], v142 offset:15360
    ds_read_b64_tr_b16 v[114:115], v142 offset:16128
    s_waitcnt lgkmcnt(6)
    v_mfma_f32_32x32x16_bf16 v[88:103], v[180:183], v[116:119], v[88:103]
    buffer_load_dwordx4 v[180:183], v6, s[56:59], s34 offen offset:0
    s_nop 0
    v_mul_f32 v64, 0xc0135761, v41
    v_mul_f32 v41, v41, v41
    v_mul_f32 v41, 0x3d372713, v41
    v_mul_f32 v65, v41, v64
    ds_read_b64_tr_b16 v[116:117], v141 offset:12352
    ds_read_b64_tr_b16 v[118:119], v141 offset:13120
    s_waitcnt lgkmcnt(6)
    v_mfma_f32_32x32x16_bf16 v[72:87], v[216:219], v[104:107], v[72:87]
    s_waitcnt vmcnt(11)
    v_cndmask_b32 v137, 0, v140, s[50:51]
    s_nop 1
    ds_read_b64_tr_b16 v[104:105], v142 offset:18432
    ds_read_b64_tr_b16 v[106:107], v142 offset:19200
    s_waitcnt lgkmcnt(6)
    v_mfma_f32_32x32x16_bf16 v[88:103], v[184:187], v[108:111], v[88:103]
    buffer_load_dwordx4 v[184:187], v6, s[56:59], s33 offen offset:1024
    ds_read_b64_tr_b16 v[108:109], v141 offset:15424
    ds_read_b64_tr_b16 v[110:111], v141 offset:16192
    s_waitcnt lgkmcnt(6)
    v_mfma_f32_32x32x16_bf16 v[72:87], v[220:223], v[112:115], v[72:87]
    ds_read_b64_tr_b16 v[112:113], v59 offset:0
    ds_read_b64_tr_b16 v[114:115], v59 offset:768
    s_waitcnt lgkmcnt(6)
    v_mfma_f32_32x32x16_bf16 v[88:103], v[188:191], v[116:119], v[88:103]
    buffer_load_dwordx4 v[188:191], v6, s[56:59], s34 offen offset:1024
    ds_read_b64_tr_b16 v[116:117], v141 offset:18496
    ds_read_b64_tr_b16 v[118:119], v141 offset:19264
    s_waitcnt lgkmcnt(6)
    v_mfma_f32_32x32x16_bf16 v[72:87], v[224:227], v[104:107], v[72:87]
    ds_read_b64_tr_b16 v[104:105], v59 offset:3072
    ds_read_b64_tr_b16 v[106:107], v59 offset:3840
    s_waitcnt lgkmcnt(6)
    v_mfma_f32_32x32x16_bf16 v[88:103], v[192:195], v[108:111], v[88:103]
    buffer_load_dwordx4 v[192:195], v6, s[56:59], s33 offen offset:2048
    ds_read_b64_tr_b16 v[108:109], v142 offset:64
    ds_read_b64_tr_b16 v[110:111], v142 offset:832
    s_waitcnt lgkmcnt(6)
    v_mfma_f32_32x32x16_bf16 v[72:87], v[228:231], v[112:115], v[72:87]
    ds_read_b64_tr_b16 v[112:113], v59 offset:6144
    ds_read_b64_tr_b16 v[114:115], v59 offset:6912
    s_waitcnt lgkmcnt(6)
    v_mfma_f32_32x32x16_bf16 v[88:103], v[196:199], v[116:119], v[88:103]
    buffer_load_dwordx4 v[196:199], v6, s[56:59], s34 offen offset:2048
    ds_read_b64_tr_b16 v[116:117], v142 offset:3136
    ds_read_b64_tr_b16 v[118:119], v142 offset:3904
    s_waitcnt lgkmcnt(6)
    v_mfma_f32_32x32x16_bf16 v[72:87], v[232:235], v[104:107], v[72:87]
    ds_read_b64_tr_b16 v[104:105], v59 offset:9216
    ds_read_b64_tr_b16 v[106:107], v59 offset:9984
    s_waitcnt lgkmcnt(6)
    v_mfma_f32_32x32x16_bf16 v[88:103], v[200:203], v[108:111], v[88:103]
    buffer_load_dwordx4 v[200:203], v6, s[56:59], s33 offen offset:3072
    s_add_u32 s33, s33, 4096
    ds_read_b64_tr_b16 v[108:109], v142 offset:6208
    ds_read_b64_tr_b16 v[110:111], v142 offset:6976
    s_waitcnt lgkmcnt(6)
    v_mfma_f32_32x32x16_bf16 v[72:87], v[236:239], v[112:115], v[72:87]
    ds_read_b64_tr_b16 v[112:113], v59 offset:12288
    ds_read_b64_tr_b16 v[114:115], v59 offset:13056
    s_waitcnt lgkmcnt(6)
    v_mfma_f32_32x32x16_bf16 v[88:103], v[204:207], v[116:119], v[88:103]
    buffer_load_dwordx4 v[204:207], v6, s[56:59], s34 offen offset:3072
    s_add_u32 s34, s34, 4096
    ds_read_b64_tr_b16 v[116:117], v142 offset:9280
    ds_read_b64_tr_b16 v[118:119], v142 offset:10048
    s_waitcnt lgkmcnt(6)
    v_mfma_f32_32x32x16_bf16 v[72:87], v[240:243], v[104:107], v[72:87]
    ds_read_b64_tr_b16 v[104:105], v59 offset:15360
    ds_read_b64_tr_b16 v[106:107], v59 offset:16128
    s_waitcnt lgkmcnt(6)
    v_mfma_f32_32x32x16_bf16 v[88:103], v[208:211], v[108:111], v[88:103]
    buffer_load_dwordx4 v[208:211], v6, s[56:59], s33 offen offset:0
    ds_read_b64_tr_b16 v[108:109], v142 offset:12352
    ds_read_b64_tr_b16 v[110:111], v142 offset:13120
    s_waitcnt lgkmcnt(6)
    v_mfma_f32_32x32x16_bf16 v[72:87], v[244:247], v[112:115], v[72:87]
    ds_read_b64_tr_b16 v[112:113], v59 offset:18432
    ds_read_b64_tr_b16 v[114:115], v59 offset:19200
    s_waitcnt lgkmcnt(6)
    v_mfma_f32_32x32x16_bf16 v[88:103], v[212:215], v[116:119], v[88:103]
    buffer_load_dwordx4 v[212:215], v6, s[56:59], s34 offen offset:0
    ds_read_b64_tr_b16 v[116:117], v142 offset:15424
    ds_read_b64_tr_b16 v[118:119], v142 offset:16192
    s_waitcnt lgkmcnt(6)
    v_mfma_f32_32x32x16_bf16 v[72:87], v[248:251], v[104:107], v[72:87]
    ds_read_b64_tr_b16 v[104:105], v142 offset:18496
    ds_read_b64_tr_b16 v[106:107], v142 offset:19264
    s_waitcnt lgkmcnt(6)
    v_mfma_f32_32x32x16_bf16 v[88:103], v[216:219], v[108:111], v[88:103]
    buffer_load_dwordx4 v[216:219], v6, s[56:59], s33 offen offset:1024
    ds_read_b64_tr_b16 v[108:109], v59 offset:64
    ds_read_b64_tr_b16 v[110:111], v59 offset:832
    s_waitcnt lgkmcnt(6)
    v_mfma_f32_32x32x16_bf16 v[72:87], v[252:255], v[112:115], v[72:87]
    v_mfma_f32_32x32x16_bf16 v[72:87], v[136:139], v[44:47], v[72:87]
    buffer_load_dword v67, v5, s[68:71], s74 offen sc1
    ds_read_b64_tr_b16 v[112:113], v59 offset:3136
    ds_read_b64_tr_b16 v[114:115], v59 offset:3904
    s_waitcnt lgkmcnt(6)
    v_mfma_f32_32x32x16_bf16 v[88:103], v[220:223], v[116:119], v[88:103]
    buffer_load_dwordx4 v[220:223], v6, s[56:59], s34 offen offset:1024
    ds_read_b64_tr_b16 v[116:117], v59 offset:6208
    ds_read_b64_tr_b16 v[118:119], v59 offset:6976
    s_waitcnt lgkmcnt(6)
    v_mfma_f32_32x32x16_bf16 v[88:103], v[224:227], v[104:107], v[88:103]
    buffer_load_dwordx4 v[224:227], v6, s[56:59], s33 offen offset:2048
    v_mul_f32 v8, v72, v72
    v_mul_f32 v9, v73, v73
    v_mul_f32 v10, v74, v74
    v_mul_f32 v11, v75, v75
    v_mul_f32 v12, v76, v76
    v_mul_f32 v13, v77, v77
    v_mul_f32 v14, v78, v78
    v_mul_f32 v15, v79, v79
    ds_read_b64_tr_b16 v[104:105], v59 offset:9280
    ds_read_b64_tr_b16 v[106:107], v59 offset:10048
    s_waitcnt lgkmcnt(6)
    v_mfma_f32_32x32x16_bf16 v[88:103], v[228:231], v[108:111], v[88:103]
    buffer_load_dwordx4 v[228:231], v6, s[56:59], s34 offen offset:2048
    v_fma_f32 v8, v8, v53, v52
    v_fma_f32 v9, v9, v53, v52
    v_fma_f32 v10, v10, v53, v52
    v_fma_f32 v11, v11, v53, v52
    v_fma_f32 v12, v12, v53, v52
    v_fma_f32 v13, v13, v53, v52
    v_fma_f32 v14, v14, v53, v52
    v_fma_f32 v15, v15, v53, v52
    ds_read_b64_tr_b16 v[108:109], v59 offset:12352
    ds_read_b64_tr_b16 v[110:111], v59 offset:13120
    s_waitcnt lgkmcnt(6)
    v_mfma_f32_32x32x16_bf16 v[88:103], v[232:235], v[112:115], v[88:103]
    buffer_load_dwordx4 v[232:235], v6, s[56:59], s33 offen offset:3072
    s_add_u32 s33, s33, 4096
    v_mul_f32 v8, v8, v72
    v_mul_f32 v9, v9, v73
    v_mul_f32 v10, v10, v74
    v_mul_f32 v11, v11, v75
    v_mul_f32 v12, v12, v76
    v_mul_f32 v13, v13, v77
    v_mul_f32 v14, v14, v78
    v_mul_f32 v15, v15, v79
    ds_read_b64_tr_b16 v[112:113], v59 offset:15424
    ds_read_b64_tr_b16 v[114:115], v59 offset:16192
    s_waitcnt lgkmcnt(6)
    v_mfma_f32_32x32x16_bf16 v[88:103], v[236:239], v[116:119], v[88:103]
    buffer_load_dwordx4 v[236:239], v6, s[56:59], s34 offen offset:3072
    s_add_u32 s34, s34, 4096
    v_exp_f32 v8, v8
    v_exp_f32 v9, v9
    v_exp_f32 v10, v10
    v_exp_f32 v11, v11
    v_exp_f32 v12, v12
    v_exp_f32 v13, v13
    v_exp_f32 v14, v14
    v_exp_f32 v15, v15
    ds_read_b64_tr_b16 v[116:117], v59 offset:18496
    ds_read_b64_tr_b16 v[118:119], v59 offset:19264
    s_waitcnt lgkmcnt(6)
    v_mfma_f32_32x32x16_bf16 v[88:103], v[240:243], v[104:107], v[88:103]
    buffer_load_dwordx4 v[240:243], v6, s[56:59], s33 offen offset:0
    v_fma_f32 v8, v8, v54, v54
    v_fma_f32 v9, v9, v54, v54
    v_fma_f32 v10, v10, v54, v54
    v_fma_f32 v11, v11, v54, v54
    v_fma_f32 v12, v12, v54, v54
    v_fma_f32 v13, v13, v54, v54
    v_fma_f32 v14, v14, v54, v54
    v_fma_f32 v15, v15, v54, v54
    s_waitcnt lgkmcnt(4)
    v_mfma_f32_32x32x16_bf16 v[88:103], v[244:247], v[108:111], v[88:103]
    buffer_load_dwordx4 v[244:247], v6, s[56:59], s34 offen offset:0
    v_rcp_f32 v8, v8
    v_rcp_f32 v9, v9
    v_rcp_f32 v10, v10
    v_rcp_f32 v11, v11
    v_rcp_f32 v12, v12
    v_rcp_f32 v13, v13
    v_rcp_f32 v14, v14
    v_rcp_f32 v15, v15
    s_waitcnt lgkmcnt(2)
    v_mfma_f32_32x32x16_bf16 v[88:103], v[248:251], v[112:115], v[88:103]
    buffer_load_dwordx4 v[248:251], v6, s[56:59], s33 offen offset:1024
    v_mul_f32 v8, v8, v72
    v_mul_f32 v9, v9, v73
    v_mul_f32 v10, v10, v74
    v_mul_f32 v11, v11, v75
    v_mul_f32 v12, v12, v76
    v_mul_f32 v13, v13, v77
    v_mul_f32 v14, v14, v78
    v_mul_f32 v15, v15, v79
    s_waitcnt lgkmcnt(0)
    v_mfma_f32_32x32x16_bf16 v[88:103], v[252:255], v[116:119], v[88:103]
    buffer_load_dwordx4 v[252:255], v6, s[56:59], s34 offen offset:1024
    v_cvt_pk_bf16_f32 v120, v8, v9
    v_cvt_pk_bf16_f32 v121, v10, v11
    v_cvt_pk_bf16_f32 v122, v12, v13
    v_cvt_pk_bf16_f32 v123, v14, v15
    buffer_store_dwordx4 v[120:123], v6, s[16:19], s48 offen offset:0
    v_mul_f32 v16, v80, v80
    v_mul_f32 v17, v81, v81
    v_mul_f32 v18, v82, v82
    v_mfma_f32_32x32x16_bf16 v[88:103], v[136:139], v[48:51], v[88:103]
    v_mul_f32 v19, v83, v83
    v_mul_f32 v20, v84, v84
    v_mul_f32 v21, v85, v85
    v_mul_f32 v22, v86, v86
    v_mul_f32 v23, v87, v87
    v_fma_f32 v16, v16, v53, v52
    v_fma_f32 v17, v17, v53, v52
    v_fma_f32 v18, v18, v53, v52
    v_fma_f32 v19, v19, v53, v52
    v_fma_f32 v20, v20, v53, v52
    v_fma_f32 v21, v21, v53, v52
    v_fma_f32 v22, v22, v53, v52
    v_fma_f32 v23, v23, v53, v52
    v_mul_f32 v16, v16, v80
    v_mul_f32 v17, v17, v81
    v_mul_f32 v18, v18, v82
    v_mul_f32 v19, v19, v83
    v_mul_f32 v20, v20, v84
    v_mul_f32 v21, v21, v85
    v_mul_f32 v22, v22, v86
    v_mul_f32 v23, v23, v87
    v_exp_f32 v16, v16
    v_exp_f32 v17, v17
    v_exp_f32 v18, v18
    v_exp_f32 v19, v19
    v_exp_f32 v20, v20
    v_exp_f32 v21, v21
    v_exp_f32 v22, v22
    v_exp_f32 v23, v23
    v_fma_f32 v16, v16, v54, v54
    v_fma_f32 v17, v17, v54, v54
    v_fma_f32 v18, v18, v54, v54
    v_fma_f32 v19, v19, v54, v54
    v_fma_f32 v20, v20, v54, v54
    v_fma_f32 v21, v21, v54, v54
    v_fma_f32 v22, v22, v54, v54
    v_fma_f32 v23, v23, v54, v54
    v_rcp_f32 v16, v16
    v_rcp_f32 v17, v17
    v_rcp_f32 v18, v18
    v_rcp_f32 v19, v19
    v_rcp_f32 v20, v20
    v_rcp_f32 v21, v21
    v_rcp_f32 v22, v22
    v_rcp_f32 v23, v23
    v_mul_f32 v16, v16, v80
    v_mul_f32 v17, v17, v81
    v_mul_f32 v18, v18, v82
    v_mul_f32 v19, v19, v83
    v_mul_f32 v20, v20, v84
    v_mul_f32 v21, v21, v85
    v_mul_f32 v22, v22, v86
    v_mul_f32 v23, v23, v87
    v_cvt_pk_bf16_f32 v124, v16, v17
    v_cvt_pk_bf16_f32 v125, v18, v19
    v_cvt_pk_bf16_f32 v126, v20, v21
    v_cvt_pk_bf16_f32 v127, v22, v23
    buffer_store_dwordx4 v[124:127], v6, s[16:19], s48 offen offset:1024
    s_add_u32 s48, s48, 114688
    v_pk_mul_f32 v[8:9], v[88:89], v[88:89]
    v_pk_mul_f32 v[10:11], v[90:91], v[90:91]
    v_pk_mul_f32 v[12:13], v[92:93], v[92:93]
    v_pk_mul_f32 v[14:15], v[94:95], v[94:95]
    v_pk_fma_f32 v[8:9], v[8:9], v[64:65], v[64:65] op_sel:[0,1,0] op_sel_hi:[1,1,0]
    v_pk_fma_f32 v[10:11], v[10:11], v[64:65], v[64:65] op_sel:[0,1,0] op_sel_hi:[1,1,0]
    v_pk_fma_f32 v[12:13], v[12:13], v[64:65], v[64:65] op_sel:[0,1,0] op_sel_hi:[1,1,0]
    v_pk_fma_f32 v[14:15], v[14:15], v[64:65], v[64:65] op_sel:[0,1,0] op_sel_hi:[1,1,0]
    v_pk_mul_f32 v[8:9], v[8:9], v[88:89]
    v_pk_mul_f32 v[10:11], v[10:11], v[90:91]
    v_pk_mul_f32 v[12:13], v[12:13], v[92:93]
    v_pk_mul_f32 v[14:15], v[14:15], v[94:95]
    v_exp_f32 v8, v8
    v_exp_f32 v9, v9
    v_exp_f32 v10, v10
    v_exp_f32 v11, v11
    v_exp_f32 v12, v12
    v_exp_f32 v13, v13
    v_exp_f32 v14, v14
    v_exp_f32 v15, v15
    v_pk_fma_f32 v[8:9], v[8:9], v[66:67], v[66:67] op_sel_hi:[1,0,0]
    v_pk_fma_f32 v[10:11], v[10:11], v[66:67], v[66:67] op_sel_hi:[1,0,0]
    v_pk_fma_f32 v[12:13], v[12:13], v[66:67], v[66:67] op_sel_hi:[1,0,0]
    v_pk_fma_f32 v[14:15], v[14:15], v[66:67], v[66:67] op_sel_hi:[1,0,0]
    v_rcp_f32 v8, v8
    v_rcp_f32 v9, v9
    v_rcp_f32 v10, v10
    v_rcp_f32 v11, v11
    v_rcp_f32 v12, v12
    v_rcp_f32 v13, v13
    v_rcp_f32 v14, v14
    v_rcp_f32 v15, v15
    v_pk_mul_f32 v[8:9], v[8:9], v[88:89]
    v_pk_mul_f32 v[10:11], v[10:11], v[90:91]
    v_pk_mul_f32 v[12:13], v[12:13], v[92:93]
    v_pk_mul_f32 v[14:15], v[14:15], v[94:95]
    v_cvt_pk_bf16_f32 v128, v8, v9
    v_cvt_pk_bf16_f32 v129, v10, v11
    v_cvt_pk_bf16_f32 v130, v12, v13
    v_cvt_pk_bf16_f32 v131, v14, v15
    buffer_store_dwordx4 v[128:131], v6, s[16:19], s48 offen offset:0
    v_pk_mul_f32 v[16:17], v[96:97], v[96:97]
    v_pk_mul_f32 v[18:19], v[98:99], v[98:99]
    v_pk_mul_f32 v[20:21], v[100:101], v[100:101]
    v_pk_mul_f32 v[22:23], v[102:103], v[102:103]
    v_pk_fma_f32 v[16:17], v[16:17], v[64:65], v[64:65] op_sel:[0,1,0] op_sel_hi:[1,1,0]
    v_pk_fma_f32 v[18:19], v[18:19], v[64:65], v[64:65] op_sel:[0,1,0] op_sel_hi:[1,1,0]
    v_pk_fma_f32 v[20:21], v[20:21], v[64:65], v[64:65] op_sel:[0,1,0] op_sel_hi:[1,1,0]
    v_pk_fma_f32 v[22:23], v[22:23], v[64:65], v[64:65] op_sel:[0,1,0] op_sel_hi:[1,1,0]
    v_pk_mul_f32 v[16:17], v[16:17], v[96:97]
    v_pk_mul_f32 v[18:19], v[18:19], v[98:99]
    v_pk_mul_f32 v[20:21], v[20:21], v[100:101]
    v_pk_mul_f32 v[22:23], v[22:23], v[102:103]
    v_exp_f32 v16, v16
    v_exp_f32 v17, v17
    v_exp_f32 v18, v18
    v_exp_f32 v19, v19
    v_exp_f32 v20, v20
    v_exp_f32 v21, v21
    v_exp_f32 v22, v22
    v_exp_f32 v23, v23
    v_pk_fma_f32 v[16:17], v[16:17], v[66:67], v[66:67] op_sel_hi:[1,0,0]
    v_pk_fma_f32 v[18:19], v[18:19], v[66:67], v[66:67] op_sel_hi:[1,0,0]
    v_pk_fma_f32 v[20:21], v[20:21], v[66:67], v[66:67] op_sel_hi:[1,0,0]
    v_pk_fma_f32 v[22:23], v[22:23], v[66:67], v[66:67] op_sel_hi:[1,0,0]
    v_rcp_f32 v16, v16
    v_rcp_f32 v17, v17
    v_rcp_f32 v18, v18
    v_rcp_f32 v19, v19
    v_rcp_f32 v20, v20
    v_rcp_f32 v21, v21
    v_rcp_f32 v22, v22
    v_rcp_f32 v23, v23
    v_pk_mul_f32 v[16:17], v[16:17], v[96:97]
    v_pk_mul_f32 v[18:19], v[18:19], v[98:99]
    v_pk_mul_f32 v[20:21], v[20:21], v[100:101]
    v_pk_mul_f32 v[22:23], v[22:23], v[102:103]
    v_cvt_pk_bf16_f32 v132, v16, v17
    v_cvt_pk_bf16_f32 v133, v18, v19
    v_cvt_pk_bf16_f32 v134, v20, v21
    v_cvt_pk_bf16_f32 v135, v22, v23
    buffer_store_dwordx4 v[132:135], v6, s[16:19], s48 offen offset:1024
    s_add_u32 s48, s48, 114688
    s_mov_b32 s75, 400000
    s_waitcnt vmcnt(0)
K3_TABCHK:
    v_cmp_eq_u32 vcc, s72, v67
    s_cmp_eq_u64 vcc, exec
    s_cbranch_scc1 K3_FAST
    v_cmp_eq_u32 vcc, 0, v67
    s_cmp_eq_u64 vcc, 0
    s_cbranch_scc1 K3_SLOW
    s_sub_u32 s75, s75, 1
    s_cbranch_scc1 K3_SLOW
    buffer_load_dword v67, v5, s[68:71], s74 offen sc1
    s_waitcnt vmcnt(0)
    s_branch K3_TABCHK
K3_SLOW:
    buffer_wbl2 sc1
    s_waitcnt vmcnt(0)
    s_mov_b64 exec, 1
    v_mov_b32 v0, 1
    buffer_atomic_add v0, off, s[68:71], s76 sc1
    s_barrier
K3_POLLS:
    v_mov_b32 v1, 0
    buffer_atomic_add v1, off, s[68:71], s77 sc0 sc1
    s_waitcnt vmcnt(0)
    v_readfirstlane_b32 s78, v1
    s_cmp_ge_u32 s78, 7
    s_cbranch_scc1 K3_POLLSD
    s_sub_u32 s75, s75, 1
    s_cbranch_scc0 K3_POLLS
K3_POLLSD:
    buffer_inv sc1
    s_branch K3_GO
K3_FAST:
    s_mov_b64 exec, 1
    v_mov_b32 v0, 1
    buffer_atomic_add v0, off, s[68:71], s76
    s_barrier
    s_add_u32 s73, s77, 0x1c00000
K3_POLLF:
    s_load_dword s78, s[4:5], s73 glc
    s_waitcnt lgkmcnt(0)
    s_cmp_ge_u32 s78, 7
    s_cbranch_scc1 K3_GO
    s_sub_u32 s75, s75, 1
    s_cbranch_scc0 K3_POLLF
K3_GO:
    s_mov_b64 exec, -1
    buffer_load_dwordx4 v[8:11], v6, s[16:19], s31 offen offset:0
    buffer_load_dwordx4 v[12:15], v6, s[16:19], s32 offen offset:0
    buffer_load_dwordx4 v[16:19], v6, s[16:19], s31 offen offset:1024
    buffer_load_dwordx4 v[20:23], v6, s[16:19], s32 offen offset:1024
    buffer_load_dwordx4 v[24:27], v6, s[16:19], s31 offen offset:2048
    buffer_load_dwordx4 v[28:31], v6, s[16:19], s32 offen offset:2048
    buffer_load_dwordx4 v[32:35], v6, s[16:19], s31 offen offset:3072
    buffer_load_dwordx4 v[36:39], v6, s[16:19], s32 offen offset:3072
    s_add_u32 s31, s31, 4096
    s_add_u32 s32, s32, 4096
    buffer_load_dwordx4 v[40:43], v6, s[16:19], s31 offen offset:0
    buffer_load_dwordx4 v[44:47], v6, s[16:19], s32 offen offset:0
    buffer_load_dwordx4 v[48:51], v6, s[16:19], s31 offen offset:1024
    buffer_load_dwordx4 v[52:55], v6, s[16:19], s32 offen offset:1024
    buffer_load_dwordx4 v[56:59], v6, s[16:19], s31 offen offset:2048
    buffer_load_dwordx4 v[60:63], v6, s[16:19], s32 offen offset:2048
    buffer_load_dwordx4 v[136:139], v6, s[16:19], s31 offen offset:3072
    buffer_load_dwordx4 v[140:143], v6, s[16:19], s32 offen offset:3072
    s_add_u32 s31, s31, 4096
    s_add_u32 s32, s32, 4096
    v_and_b32 v3, 31, v2
    v_mul_u32_u24 v3, 272, v3
    v_lshrrev_b32 v4, 5, v2
    v_lshl_add_u32 v3, v4, 4, v3
    s_mul_i32 s37, s3, 17408
    v_add_u32 v3, s37, v3
    v_and_b32 v64, 15, v2
    v_lshrrev_b32 v65, 4, v2
    s_and_b32 s38, s3, 3
    s_lshl_b32 s39, s38, 5
    s_lshl_b32 s38, s38, 4
    s_lshr_b32 s40, s3, 2
    v_add_u32 v5, s38, v64
    v_mul_u32_u24 v7, 272, v5
    v_lshl_add_u32 v7, v65, 5, v7
    s_lshl_b32 s41, s40, 7
    v_add_u32 v7, s41, v7
    v_add_u32 v66, 69632, v7
    v_lshrrev_b32 v4, 2, v64
    v_lshl_add_u32 v4, v65, 3, v4
    v_mul_u32_u24 v4, 192, v4
    v_and_b32 v64, 3, v64
    v_lshl_add_u32 v4, v64, 3, v4
    s_mul_i32 s41, s40, 6144
    s_add_u32 s39, s39, s41
    s_add_u32 s39, s39, 139264
    v_add_u32 v4, s39, v4
    v_mul_u32_u24 v5, 896, v5
    v_lshl_add_u32 v5, v65, 4, v5
    s_mul_i32 s42, s24, 57344
    s_add_u32 s42, s42, s79
    s_waitcnt vmcnt(14)
    v_mfma_f32_32x32x16_bf16 v[72:87], v[144:147], v[8:11], 0
    v_mfma_f32_32x32x16_bf16 v[88:103], v[144:147], v[12:15], 0
    v_mfma_f32_32x32x16_bf16 v[104:119], v[148:151], v[8:11], 0
    v_mfma_f32_32x32x16_bf16 v[120:135], v[148:151], v[12:15], 0
    buffer_load_dwordx4 v[8:11], v6, s[16:19], s31 offen offset:0
    buffer_load_dwordx4 v[12:15], v6, s[16:19], s32 offen offset:0
    s_waitcnt vmcnt(14)
    v_mfma_f32_32x32x16_bf16 v[72:87], v[152:155], v[16:19], v[72:87]
    v_mfma_f32_32x32x16_bf16 v[88:103], v[152:155], v[20:23], v[88:103]
    v_mfma_f32_32x32x16_bf16 v[104:119], v[156:159], v[16:19], v[104:119]
    v_mfma_f32_32x32x16_bf16 v[120:135], v[156:159], v[20:23], v[120:135]
    buffer_load_dwordx4 v[16:19], v6, s[16:19], s31 offen offset:1024
    buffer_load_dwordx4 v[20:23], v6, s[16:19], s32 offen offset:1024
    s_waitcnt vmcnt(14)
    v_mfma_f32_32x32x16_bf16 v[72:87], v[160:163], v[24:27], v[72:87]
    v_mfma_f32_32x32x16_bf16 v[88:103], v[160:163], v[28:31], v[88:103]
    v_mfma_f32_32x32x16_bf16 v[104:119], v[164:167], v[24:27], v[104:119]
    v_mfma_f32_32x32x16_bf16 v[120:135], v[164:167], v[28:31], v[120:135]
    buffer_load_dwordx4 v[24:27], v6, s[16:19], s31 offen offset:2048
    buffer_load_dwordx4 v[28:31], v6, s[16:19], s32 offen offset:2048
    s_waitcnt vmcnt(14)
    v_mfma_f32_32x32x16_bf16 v[72:87], v[168:171], v[32:35], v[72:87]
    v_mfma_f32_32x32x16_bf16 v[88:103], v[168:171], v[36:39], v[88:103]
    v_mfma_f32_32x32x16_bf16 v[104:119], v[172:175], v[32:35], v[104:119]
    v_mfma_f32_32x32x16_bf16 v[120:135], v[172:175], v[36:39], v[120:135]
    buffer_load_dwordx4 v[32:35], v6, s[16:19], s31 offen offset:3072
    buffer_load_dwordx4 v[36:39], v6, s[16:19], s32 offen offset:3072
    s_add_u32 s31, s31, 4096
    s_add_u32 s32, s32, 4096
    s_waitcnt vmcnt(14)
    v_mfma_f32_32x32x16_bf16 v[72:87], v[176:179], v[40:43], v[72:87]
    v_mfma_f32_32x32x16_bf16 v[88:103], v[176:179], v[44:47], v[88:103]
    v_mfma_f32_32x32x16_bf16 v[104:119], v[180:183], v[40:43], v[104:119]
    v_mfma_f32_32x32x16_bf16 v[120:135], v[180:183], v[44:47], v[120:135]
    buffer_load_dwordx4 v[40:43], v6, s[16:19], s31 offen offset:0
    buffer_load_dwordx4 v[44:47], v6, s[16:19], s32 offen offset:0
    s_waitcnt vmcnt(14)
    v_mfma_f32_32x32x16_bf16 v[72:87], v[184:187], v[48:51], v[72:87]
    v_mfma_f32_32x32x16_bf16 v[88:103], v[184:187], v[52:55], v[88:103]
    v_mfma_f32_32x32x16_bf16 v[104:119], v[188:191], v[48:51], v[104:119]
    v_mfma_f32_32x32x16_bf16 v[120:135], v[188:191], v[52:55], v[120:135]
    buffer_load_dwordx4 v[48:51], v6, s[16:19], s31 offen offset:1024
    buffer_load_dwordx4 v[52:55], v6, s[16:19], s32 offen offset:1024
    s_waitcnt vmcnt(14)
    v_mfma_f32_32x32x16_bf16 v[72:87], v[192:195], v[56:59], v[72:87]
    v_mfma_f32_32x32x16_bf16 v[88:103], v[192:195], v[60:63], v[88:103]
    v_mfma_f32_32x32x16_bf16 v[104:119], v[196:199], v[56:59], v[104:119]
    v_mfma_f32_32x32x16_bf16 v[120:135], v[196:199], v[60:63], v[120:135]
    s_waitcnt vmcnt(12)
    v_mfma_f32_32x32x16_bf16 v[72:87], v[200:203], v[136:139], v[72:87]
    v_mfma_f32_32x32x16_bf16 v[88:103], v[200:203], v[140:143], v[88:103]
    v_mfma_f32_32x32x16_bf16 v[104:119], v[204:207], v[136:139], v[104:119]
    v_mfma_f32_32x32x16_bf16 v[120:135], v[204:207], v[140:143], v[120:135]
    s_waitcnt vmcnt(10)
    v_mfma_f32_32x32x16_bf16 v[72:87], v[208:211], v[8:11], v[72:87]
    v_mfma_f32_32x32x16_bf16 v[88:103], v[208:211], v[12:15], v[88:103]
    v_mfma_f32_32x32x16_bf16 v[104:119], v[212:215], v[8:11], v[104:119]
    v_mfma_f32_32x32x16_bf16 v[120:135], v[212:215], v[12:15], v[120:135]
    s_waitcnt vmcnt(8)
    v_mfma_f32_32x32x16_bf16 v[72:87], v[216:219], v[16:19], v[72:87]
    v_mfma_f32_32x32x16_bf16 v[88:103], v[216:219], v[20:23], v[88:103]
    v_mfma_f32_32x32x16_bf16 v[104:119], v[220:223], v[16:19], v[104:119]
    v_mfma_f32_32x32x16_bf16 v[120:135], v[220:223], v[20:23], v[120:135]
    s_waitcnt vmcnt(6)
    v_mfma_f32_32x32x16_bf16 v[72:87], v[224:227], v[24:27], v[72:87]
    v_mfma_f32_32x32x16_bf16 v[88:103], v[224:227], v[28:31], v[88:103]
    v_mfma_f32_32x32x16_bf16 v[104:119], v[228:231], v[24:27], v[104:119]
    v_mfma_f32_32x32x16_bf16 v[120:135], v[228:231], v[28:31], v[120:135]
    s_waitcnt vmcnt(4)
    v_mfma_f32_32x32x16_bf16 v[72:87], v[232:235], v[32:35], v[72:87]
    v_mfma_f32_32x32x16_bf16 v[88:103], v[232:235], v[36:39], v[88:103]
    v_mfma_f32_32x32x16_bf16 v[104:119], v[236:239], v[32:35], v[104:119]
    v_mfma_f32_32x32x16_bf16 v[120:135], v[236:239], v[36:39], v[120:135]
    s_waitcnt vmcnt(2)
    v_mfma_f32_32x32x16_bf16 v[72:87], v[240:243], v[40:43], v[72:87]
    v_mfma_f32_32x32x16_bf16 v[88:103], v[240:243], v[44:47], v[88:103]
    v_mfma_f32_32x32x16_bf16 v[104:119], v[244:247], v[40:43], v[104:119]
    v_mfma_f32_32x32x16_bf16 v[120:135], v[244:247], v[44:47], v[120:135]
    s_waitcnt vmcnt(0)
    v_mfma_f32_32x32x16_bf16 v[72:87], v[248:251], v[48:51], v[72:87]
    v_mfma_f32_32x32x16_bf16 v[88:103], v[248:251], v[52:55], v[88:103]
    v_mfma_f32_32x32x16_bf16 v[104:119], v[252:255], v[48:51], v[104:119]
    v_mfma_f32_32x32x16_bf16 v[120:135], v[252:255], v[52:55], v[120:135]
    s_nop 9
    ds_write_b128 v3, v[72:75] offset:0
    ds_write_b128 v3, v[76:79] offset:32
    ds_write_b128 v3, v[80:83] offset:64
    ds_write_b128 v3, v[84:87] offset:96
    ds_write_b128 v3, v[88:91] offset:8704
    ds_write_b128 v3, v[92:95] offset:8736
    ds_write_b128 v3, v[96:99] offset:8768
    ds_write_b128 v3, v[100:103] offset:8800
    ds_write_b128 v3, v[104:107] offset:128
    ds_write_b128 v3, v[108:111] offset:160
    ds_write_b128 v3, v[112:115] offset:192
    ds_write_b128 v3, v[116:119] offset:224
    s_nop 3
    ds_write_b128 v3, v[120:123] offset:8832
    ds_write_b128 v3, v[124:127] offset:8864
    ds_write_b128 v3, v[128:131] offset:8896
    ds_write_b128 v3, v[132:135] offset:8928
    s_waitcnt lgkmcnt(0)
    s_barrier
    ds_read_b128 v[72:75], v7 offset:0
    ds_read_b128 v[76:79], v7 offset:16
    ds_read_b128 v[80:83], v7 offset:17408
    ds_read_b128 v[84:87], v7 offset:17424
    ds_read_b128 v[88:91], v7 offset:34816
    ds_read_b128 v[92:95], v7 offset:34832
    ds_read_b128 v[96:99], v7 offset:52224
    ds_read_b128 v[100:103], v7 offset:52240
    ds_read_b128 v[104:107], v66 offset:0
    ds_read_b128 v[108:111], v66 offset:16
    ds_read_b128 v[112:115], v66 offset:17408
    ds_read_b128 v[116:119], v66 offset:17424
    ds_read_b128 v[120:123], v66 offset:34816
    ds_read_b128 v[124:127], v66 offset:34832
    ds_read_b128 v[128:131], v66 offset:52224
    ds_read_b128 v[132:135], v66 offset:52240
    ds_read_b64_tr_b16 v[48:49], v4
    ds_read_b64_tr_b16 v[50:51], v4 offset:768
    s_waitcnt lgkmcnt(14)
    v_pk_add_f32 v[72:73], v[72:73], v[80:81]
    v_pk_add_f32 v[74:75], v[74:75], v[82:83]
    v_pk_add_f32 v[76:77], v[76:77], v[84:85]
    v_pk_add_f32 v[78:79], v[78:79], v[86:87]
    s_waitcnt lgkmcnt(10)
    v_pk_add_f32 v[88:89], v[88:89], v[96:97]
    v_pk_add_f32 v[90:91], v[90:91], v[98:99]
    v_pk_add_f32 v[92:93], v[92:93], v[100:101]
    v_pk_add_f32 v[94:95], v[94:95], v[102:103]
    s_waitcnt lgkmcnt(6)
    v_pk_add_f32 v[104:105], v[104:105], v[112:113]
    v_pk_add_f32 v[106:107], v[106:107], v[114:115]
    v_pk_add_f32 v[108:109], v[108:109], v[116:117]
    v_pk_add_f32 v[110:111], v[110:111], v[118:119]
    s_waitcnt lgkmcnt(2)
    v_pk_add_f32 v[120:121], v[120:121], v[128:129]
    v_pk_add_f32 v[122:123], v[122:123], v[130:131]
    v_pk_add_f32 v[124:125], v[124:125], v[132:133]
    v_pk_add_f32 v[126:127], v[126:127], v[134:135]
    v_pk_add_f32 v[72:73], v[72:73], v[88:89]
    v_pk_add_f32 v[74:75], v[74:75], v[90:91]
    v_pk_add_f32 v[76:77], v[76:77], v[92:93]
    v_pk_add_f32 v[78:79], v[78:79], v[94:95]
    v_pk_add_f32 v[104:105], v[104:105], v[120:121]
    v_pk_add_f32 v[106:107], v[106:107], v[122:123]
    v_pk_add_f32 v[108:109], v[108:109], v[124:125]
    v_pk_add_f32 v[110:111], v[110:111], v[126:127]
    v_pk_add_f32 v[72:73], v[72:73], v[104:105]
    v_pk_add_f32 v[74:75], v[74:75], v[106:107]
    v_pk_add_f32 v[76:77], v[76:77], v[108:109]
    v_pk_add_f32 v[78:79], v[78:79], v[110:111]
    s_waitcnt lgkmcnt(0)
    v_cvt_pk_bf16_f32 v24, v72, v73
    v_and_b32 v25, s47, v24
    v_lshlrev_b32 v24, 16, v24
    v_lshlrev_b32 v26, 16, v68
    v_and_b32 v27, s47, v68
    v_add_f32 v24, v24, v26
    v_add_f32 v25, v25, v27
    v_cvt_pk_bf16_f32 v24, v24, v25
    v_and_b32 v25, s47, v24
    v_lshlrev_b32 v24, 16, v24
    v_lshlrev_b32 v26, 16, v48
    v_and_b32 v27, s47, v48
    v_add_f32 v24, v24, v26
    v_add_f32 v25, v25, v27
    v_cvt_pk_bf16_f32 v52, v24, v25
    v_cvt_pk_bf16_f32 v24, v74, v75
    v_and_b32 v25, s47, v24
    v_lshlrev_b32 v24, 16, v24
    v_lshlrev_b32 v26, 16, v69
    v_and_b32 v27, s47, v69
    v_add_f32 v24, v24, v26
    v_add_f32 v25, v25, v27
    v_cvt_pk_bf16_f32 v24, v24, v25
    v_and_b32 v25, s47, v24
    v_lshlrev_b32 v24, 16, v24
    v_lshlrev_b32 v26, 16, v49
    v_and_b32 v27, s47, v49
    v_add_f32 v24, v24, v26
    v_add_f32 v25, v25, v27
    v_cvt_pk_bf16_f32 v53, v24, v25
    v_cvt_pk_bf16_f32 v24, v76, v77
    v_and_b32 v25, s47, v24
    v_lshlrev_b32 v24, 16, v24
    v_lshlrev_b32 v26, 16, v70
    v_and_b32 v27, s47, v70
    v_add_f32 v24, v24, v26
    v_add_f32 v25, v25, v27
    v_cvt_pk_bf16_f32 v24, v24, v25
    v_and_b32 v25, s47, v24
    v_lshlrev_b32 v24, 16, v24
    v_lshlrev_b32 v26, 16, v50
    v_and_b32 v27, s47, v50
    v_add_f32 v24, v24, v26
    v_add_f32 v25, v25, v27
    v_cvt_pk_bf16_f32 v54, v24, v25
    v_cvt_pk_bf16_f32 v24, v78, v79
    v_and_b32 v25, s47, v24
    v_lshlrev_b32 v24, 16, v24
    v_lshlrev_b32 v26, 16, v71
    v_and_b32 v27, s47, v71
    v_add_f32 v24, v24, v26
    v_add_f32 v25, v25, v27
    v_cvt_pk_bf16_f32 v24, v24, v25
    v_and_b32 v25, s47, v24
    v_lshlrev_b32 v24, 16, v24
    v_lshlrev_b32 v26, 16, v51
    v_and_b32 v27, s47, v51
    v_add_f32 v24, v24, v26
    v_add_f32 v25, v25, v27
    v_cvt_pk_bf16_f32 v55, v24, v25
    buffer_store_dwordx4 v[52:55], v5, s[64:67], s42 offen
    s_endpgm
K1_ZERO:
    s_barrier
    s_cmp_eq_u32 s41, -1
    s_cbranch_scc1 K1_ZE
    buffer_load_dwordx4 v[240:243], v83, s[28:31], s8 offen
    s_add_u32 s8, s8, 28672
    buffer_load_dwordx4 v[244:247], v83, s[28:31], s8 offen
    s_add_u32 s8, s8, 28672
    buffer_load_dwordx4 v[248:251], v83, s[28:31], s8 offen
    s_add_u32 s8, s8, 28672
    buffer_load_dwordx4 v[252:255], v83, s[28:31], s8 offen
    s_waitcnt vmcnt(0)
    ds_write_b128 v210, v[224:227] offset:0
    ds_write_b128 v210, v[228:231] offset:1536
    ds_write_b128 v210, v[232:235] offset:3072
    ds_write_b128 v210, v[236:239] offset:4608
    ds_write_b128 v210, v[240:243] offset:6144
    ds_write_b128 v210, v[244:247] offset:7680
    ds_write_b128 v210, v[248:251] offset:9216
    ds_write_b128 v210, v[252:255] offset:10752
    s_waitcnt lgkmcnt(0)
    ds_read_b64_tr_b16 v[224:225], v207 offset:0
    ds_read_b64_tr_b16 v[226:227], v208 offset:0
    ds_read_b64_tr_b16 v[228:229], v207 offset:3072
    ds_read_b64_tr_b16 v[230:231], v208 offset:3072
    ds_read_b64_tr_b16 v[232:233], v207 offset:6144
    ds_read_b64_tr_b16 v[234:235], v208 offset:6144
    ds_read_b64_tr_b16 v[236:237], v207 offset:9216
    ds_read_b64_tr_b16 v[238:239], v208 offset:9216
    ds_read_b64_tr_b16 v[240:241], v207 offset:64
    ds_read_b64_tr_b16 v[242:243], v208 offset:64
    ds_read_b64_tr_b16 v[244:245], v207 offset:3136
    ds_read_b64_tr_b16 v[246:247], v208 offset:3136
    ds_read_b64_tr_b16 v[248:249], v207 offset:6208
    ds_read_b64_tr_b16 v[250:251], v208 offset:6208
    ds_read_b64_tr_b16 v[252:253], v207 offset:9280
    ds_read_b64_tr_b16 v[254:255], v208 offset:9280
    s_waitcnt lgkmcnt(14)
    buffer_store_dwordx4 v[224:227], v213, s[68:71], s9 offen offset:0 sc1
    s_waitcnt lgkmcnt(12)
    buffer_store_dwordx4 v[228:231], v213, s[68:71], s9 offen offset:1024 sc1
    s_waitcnt lgkmcnt(10)
    buffer_store_dwordx4 v[232:235], v213, s[68:71], s9 offen offset:2048 sc1
    s_waitcnt lgkmcnt(8)
    buffer_store_dwordx4 v[236:239], v213, s[68:71], s9 offen offset:3072 sc1
    s_add_u32 s9, s9, 28672
    s_waitcnt lgkmcnt(6)
    buffer_store_dwordx4 v[240:243], v213, s[68:71], s9 offen offset:0 sc1
    s_waitcnt lgkmcnt(4)
    buffer_store_dwordx4 v[244:247], v213, s[68:71], s9 offen offset:1024 sc1
    s_waitcnt lgkmcnt(2)
    buffer_store_dwordx4 v[248:251], v213, s[68:71], s9 offen offset:2048 sc1
    s_waitcnt lgkmcnt(0)
    buffer_store_dwordx4 v[252:255], v213, s[68:71], s9 offen offset:3072 sc1
    s_waitcnt vmcnt(0)
    s_mov_b32 exec_lo, -1
    s_mov_b32 exec_hi, 0
    buffer_store_dword v192, v209, s[68:71], s10 offen sc1
    s_mov_b64 exec, -1
K1_ZE:
    s_load_dwordx2 s[88:89], s[0:1], 72
    s_load_dwordx4 s[80:83], s[0:1], 88
    v_lshlrev_b32 v3, 7, v2
    s_waitcnt lgkmcnt(0)
    s_cmp_lg_u32 s3, 7
    s_cbranch_scc1 K1_ZB
    s_mov_b32 s24, s88
    s_mov_b32 s25, s89
    s_and_b32 s25, s25, 0xffff
    s_mov_b32 s26, 0xe00
    s_mov_b32 s27, 0x00020000
    s_mov_b32 s28, s80
    s_mov_b32 s29, s81
    s_and_b32 s29, s29, 0xffff
    s_mov_b32 s30, 0x380
    s_mov_b32 s31, 0x00020000
    s_mov_b64 exec, 0xfffffff
    buffer_load_dword v8, v3, s[24:27], 0 offen
    s_mov_b64 exec, 0x7f
    buffer_load_dword v9, v3, s[28:31], 0 offen
    s_mov_b64 exec, -1
K1_ZB:
    s_barrier
    s_sub_u32 s22, s2, 224
    s_lshl_b32 s22, s22, 3
    s_add_u32 s22, s22, s3
    s_mul_i32 s22, s22, 28672
    s_add_u32 s22, s22, 0x1000000
    v_lshlrev_b32 v3, 7, v2
    s_mov_b64 exec, s[62:63]
    buffer_load_dword v4, v3, s[68:71], s22 offen
    s_add_u32 s22, s22, 7168
    buffer_load_dword v5, v3, s[68:71], s22 offen
    s_add_u32 s22, s22, 7168
    buffer_load_dword v6, v3, s[68:71], s22 offen
    s_add_u32 s22, s22, 7168
    buffer_load_dword v7, v3, s[68:71], s22 offen
    s_add_u32 s22, s22, 7168
    s_mov_b32 s24, s82
    s_mov_b32 s25, s83
    s_and_b32 s25, s25, 0xffff
    s_mov_b32 s26, 0x1c0000
    s_mov_b32 s27, 0x00020000
    s_sub_u32 s22, s2, 224
    s_lshl_b32 s22, s22, 3
    s_add_u32 s22, s22, s3
    s_mul_i32 s22, s22, 7168
    buffer_load_dword v10, v3, s[24:27], s22 offen
    s_mov_b64 exec, -1
    s_waitcnt vmcnt(0)
    s_endpgm
K1_EXIT:
    s_endpgm
.section .rodata,"a"
.p2align 6
.amdhsa_kernel sequential_preLN__ssm_conv_s4d__dense_activation_gelu__prompt_kernel
  .amdhsa_next_free_vgpr 256
  .amdhsa_next_free_sgpr 102
  .amdhsa_accum_offset 256
  .amdhsa_group_segment_fixed_size 0
  .amdhsa_kernarg_size 120
  .amdhsa_user_sgpr_count 2
  .amdhsa_user_sgpr_kernarg_segment_ptr 1
  .amdhsa_system_sgpr_workgroup_id_x 1
.end_amdhsa_kernel
```
